```python
import torch

def _softmax(x, axis=-1):
    return torch.softmax(x, dim=axis)
def _gelu(x):
    return torch.nn.functional.gelu(x, approximate="tanh")
def _silu(x):
    return torch.nn.functional.silu(x)
def _sigmoid(x):
    return torch.sigmoid(x)
def _layernorm(x, axis=-1, eps=1e-5):
    m = x.mean(dim=axis, keepdim=True)
    v = x.var(dim=axis, keepdim=True, unbiased=False)
    return (x - m) / torch.sqrt(v + eps)
def _scatter_add(tgt, idx, src, axis=0):
    return tgt.clone().index_add_(axis, idx, src)
def _segment_sum(src, seg, n):
    out = torch.zeros((n,) + src.shape[1:], dtype=src.dtype)
    return out.index_add_(0, seg, src)
def _pad(x, pw):
    flat = tuple(v for pair in reversed(pw) for v in pair)
    return torch.nn.functional.pad(x, flat)

kernel_name = 'gated_mix__linear_attn_block__ssm_conv_s4__prompt'

def setup_inputs():

    _w = (lambda a: (lambda t: t.to(torch.bfloat16) if t.is_floating_point() else t)(torch.as_tensor(a)))
    def _A_setup():
        B, S, D = 1, 2048, 512
        return {
            "x": _w((lambda *s: torch.randn(*s, dtype=torch.bfloat16) * 0.05)(B, S, D)),
            "wqkv": _w((lambda *s: torch.randn(*s, dtype=torch.bfloat16) * 0.8)(D, 3 * D)),
            "wo": _w((lambda *s: torch.randn(*s, dtype=torch.bfloat16) * 0.05)(D, D)),
        }
    _A_in = _A_setup()

    def _B_setup():
        B, L, D, N = 1, 2048, 512, 128
        A_re = -(lambda _x: torch.exp(torch.as_tensor(_x)))((lambda *s: torch.randn(*s, dtype=torch.bfloat16) * 3.2)(D, N))
        A_im = torch.pi * (lambda *s: torch.randn(*s, dtype=torch.bfloat16) * 0.05)(D, N)
        B_re = (lambda *s: torch.randn(*s, dtype=torch.bfloat16) * 0.2)(D, N)
        B_im = (lambda *s: torch.randn(*s, dtype=torch.bfloat16) * 0.2)(D, N)
        C_re = (lambda *s: torch.randn(*s, dtype=torch.bfloat16) * 0.2)(D, N)
        C_im = (lambda *s: torch.randn(*s, dtype=torch.bfloat16) * 0.2)(D, N)
        log_dt = (lambda *s: torch.randn(*s, dtype=torch.bfloat16) * 0.05)(D) * 0.5 - 4.0
        Dskip = (lambda *s: torch.randn(*s, dtype=torch.bfloat16) * 0.05)(D)
        return {
            "u": _w((lambda *s: torch.randn(*s, dtype=torch.bfloat16) * 0.05)(B, L, D)),
            "A_re": _w(A_re),
            "A_im": _w(A_im),
            "B_re": _w(B_re),
            "B_im": _w(B_im),
            "C_re": _w(C_re),
            "C_im": _w(C_im),
            "log_dt": _w(log_dt),
            "Dskip": _w(Dskip),
        }
    _B_in = _B_setup()

    return {
        "A_x": _A_in["x"],
        "A_wqkv": _A_in["wqkv"],
        "A_wo": _A_in["wo"],
        "B_u": _B_in["u"],
        "B_A_re": _B_in["A_re"],
        "B_A_im": _B_in["A_im"],
        "B_B_re": _B_in["B_re"],
        "B_B_im": _B_in["B_im"],
        "B_C_re": _B_in["C_re"],
        "B_C_im": _B_in["C_im"],
        "B_log_dt": _B_in["log_dt"],
        "B_Dskip": _B_in["Dskip"],
        "gate_w": _w((lambda *s: torch.randn(*s, dtype=torch.bfloat16) * 0.05)(512) * 16.0),
    }

def reference(A_x, A_wqkv, A_wo, B_u, B_A_re, B_A_im, B_B_re, B_B_im, B_C_re, B_C_im, B_log_dt, B_Dskip, gate_w):
    def _A_ref(x, wqkv, wo):
        B, S, D = x.shape
        H = 32; Dh = D // H
        qkv = (lambda x, *d: x.permute(*d))((x @ wqkv).reshape(B, S, 3, H, Dh), 2, 0, 3, 1, 4)
        q, k, v = qkv[0], qkv[1], qkv[2]
        phi = lambda t: torch.where(t > 0, t + 1, torch.exp(t)) + 1e-6
        pq, pk = phi(q), phi(k)
        kv = torch.einsum("bhsd,bhse->bhde", pk, v)
        z = torch.einsum("bhsd->bhd", pk)
        num = torch.einsum("bhqd,bhde->bhqe", pq, kv)
        den = torch.einsum("bhqd,bhd->bhq", pq, z)[..., None] + 1e-6
        o = num / den
        return (lambda x, *d: x.permute(*d))(o, 0, 2, 1, 3).reshape(B, S, D) @ wo

    def _B_ref(u, A_re, A_im, B_re, B_im, C_re, C_im, log_dt, Dskip):
        Bsz, L, D = u.shape
        dt = torch.exp(log_dt)[:, None]
        A = A_re + 1j * A_im
        Bc = B_re + 1j * B_im
        Cc = C_re + 1j * C_im
        logdA = dt * A
        dB = dt * Bc
        l = (lambda x, dt: x.to(dt))(torch.arange(L), A_re.dtype)
        P = torch.exp(logdA[:, :, None] * l[None, None, :])
        K = torch.einsum("dn,dnl,dn->dl", Cc, P, dB).real
        L2 = 2 * L
        Kp = _pad(K, ((0, 0), (0, L)))
        up = (lambda x, *d: x.permute(*d))(u, 0, 2, 1)
        up = _pad(up, ((0, 0), (0, 0), (0, L)))
        Kf = (lambda x, axes=(-2,-1): torch.fft.rfft2(x.float(), dim=axes))(Kp[:, None, :], axes=(-2, -1))
        Uf = (lambda x, axes=(-2,-1): torch.fft.rfft2(x.float(), dim=axes))(up[:, :, None, :], axes=(-2, -1))
        Yf = Uf * Kf[None, :, :, :]
        y = (lambda x, s, axes=(-2,-1): torch.fft.irfft2(x, s=s, dim=axes).to(torch.bfloat16))(Yf, (1, L2), axes=(-2, -1))[:, :, 0, :L]
        y = (lambda x, *d: x.permute(*d))(y, 0, 2, 1) + u * Dskip[None, None, :]
        return y

    x = A_x
    g = _sigmoid((x * gate_w).sum(-1, keepdims=True))
    a = _A_ref(x, A_wqkv, A_wo)
    b = _B_ref(x, B_A_re, B_A_im, B_B_re, B_B_im, B_C_re, B_C_im, B_log_dt, B_Dskip)
    return g * a + (1 - g) * b
```

```asm
; @launch grid=(256,1,1) block=(512,1,1) lds=163840
.amdgcn_target "amdgcn-amd-amdhsa--gfx950"
.text
.globl gated_mix__linear_attn_block__ssm_conv_s4__prompt_kernel
.p2align 8
.type gated_mix__linear_attn_block__ssm_conv_s4__prompt_kernel,@function
gated_mix__linear_attn_block__ssm_conv_s4__prompt_kernel:
    s_load_dwordx16 s[16:31], s[0:1], 0
    s_load_dwordx16 s[32:47], s[0:1], 64
    s_cmp_ge_u32 s2, 256
    s_cbranch_scc1 L_exit
    v_lshrrev_b32 v1, 6, v0
    v_and_b32_e64 v0, 63, v0
    v_readfirstlane_b32 s3, v1
    s_and_b32 s4, s2, 7
    s_lshr_b32 s6, s2, 3
    s_cmp_lg_u32 s3, 3
    s_cbranch_scc1 L_nopfc
    s_getpc_b64 s[12:13]
L_pc0:
    s_sub_u32 s12, s12, L_pc0-gated_mix__linear_attn_block__ssm_conv_s4__prompt_kernel
    s_subb_u32 s13, s13, 0
    v_and_b32_e64 v1, 7, v0
    s_lshl_b32 s14, s6, 10
    v_lshl_add_u32 v1, v1, 7, s14
    v_min_u32 v1, L_end-gated_mix__linear_attn_block__ssm_conv_s4__prompt_kernel-4, v1
    global_load_dword v255, v1, s[12:13]
L_nopfc:
    s_lshr_b32 s5, s6, 1
    s_bitcmp1_b32 s6, 0
    s_cbranch_scc1 L_conv
    s_and_b32 s7, s4, 3
    s_lshl_b32 s7, s7, 2
    s_and_b32 s8, s5, 3
    s_add_u32 s7, s7, s8
    s_lshr_b32 s8, s4, 2
    s_lshl_b32 s8, s8, 2
    s_lshr_b32 s9, s5, 2
    s_add_u32 s8, s8, s9
    s_cmp_lt_u32 s3, 4
    s_cbranch_scc1 L_gcomp
    s_setprio 0
    s_sub_u32 s10, s3, 4
    v_lshrrev_b32 v1, 3, v0
    v_lshrrev_b32 v2, 4, v0
    s_and_b32 s11, s10, 1
    s_lshl_b32 s11, s11, 2
    v_add_u32 v3, s11, v2
    v_and_b32 v4, 7, v0
    v_xor_b32 v3, v3, v4
    s_lshl_b32 s12, s7, 7
    s_lshl_b32 s13, s10, 3
    s_add_u32 s12, s12, s13
    v_add_u32 v5, s12, v1
    v_lshlrev_b32_e64 v5, 10, v5
    v_lshl_add_u32 v10, v3, 4, v5
    v_and_b32 v2, 1, v2
    v_lshlrev_b32 v2, 2, v2
    v_xor_b32 v2, v2, v4
    v_add_u32 v5, s13, v1
    v_mul_u32_u24 v5, 3072, v5
    s_lshl_b32 s12, s8, 7
    v_add_u32 v5, s12, v5
    v_lshl_add_u32 v11, v2, 4, v5
    s_lshl_b32 s14, s10, 10
    s_waitcnt lgkmcnt(0)
    s_mov_b32 s48, s16
    s_mov_b32 s49, s17
    s_mov_b32 s50, 2097152
    s_mov_b32 s51, 0x20000
    s_mov_b32 s52, s18
    s_mov_b32 s53, s19
    s_mov_b32 s54, 1572864
    s_mov_b32 s55, 0x20000
    s_add_u32 m0, s14, 0
    s_mov_b32 s15, 0
    buffer_load_dwordx4 v10, s[48:51], s15 offen lds
    s_add_u32 m0, s14, 4096
    s_mov_b32 s15, 32768
    buffer_load_dwordx4 v10, s[48:51], s15 offen lds
    s_add_u32 m0, s14, 8192
    s_mov_b32 s15, 65536
    buffer_load_dwordx4 v10, s[48:51], s15 offen lds
    s_add_u32 m0, s14, 12288
    s_mov_b32 s15, 98304
    buffer_load_dwordx4 v10, s[48:51], s15 offen lds
    s_add_u32 m0, s14, 106496
    s_mov_b32 s15, 1024
    buffer_load_dwordx4 v11, s[52:55], s15 offen lds
    s_add_u32 m0, s14, 114688
    s_mov_b32 s15, 2048
    buffer_load_dwordx4 v11, s[52:55], s15 offen lds
    s_add_u32 m0, s14, 49152
    s_mov_b32 s15, 0
    s_nop 0
    buffer_load_dwordx4 v11, s[52:55], s15 offen lds
    s_add_u32 m0, s14, 110592
    s_mov_b32 s15, 99328
    buffer_load_dwordx4 v11, s[52:55], s15 offen lds
    s_add_u32 m0, s14, 118784
    s_mov_b32 s15, 100352
    buffer_load_dwordx4 v11, s[52:55], s15 offen lds
    s_add_u32 m0, s14, 53248
    s_mov_b32 s15, 98304
    buffer_load_dwordx4 v11, s[52:55], s15 offen lds
    s_mov_b32 s56, s46
    s_mov_b32 s57, s47
    s_mov_b32 s58, 6291456
    s_mov_b32 s59, 0x20000
    s_mov_b32 s60, s44
    s_mov_b32 s61, s45
    s_mov_b32 s62, 256
    s_mov_b32 s63, 0x20000
    s_mov_b32 s0, 98304
    s_mov_b32 s1, 16384
    s_mov_b32 s22, 73728
    s_mov_b32 s23, 16384
    s_mov_b32 s73, 4352
    s_mov_b32 s75, 98240
    s_lshl_b32 s64, s7, 3
    s_add_u32 s64, s64, s8
    s_lshl_b32 s64, s64, 7
    s_add_u32 s74, s64, 4292608
    s_lshl_b32 s12, s8, 1
    s_and_b32 s65, s10, 1
    s_add_u32 s12, s12, s65
    s_mul_i32 s24, s12, 98304
    s_lshl_b32 s25, s7, 6
    s_add_u32 s24, s24, s25
    s_add_u32 s24, s24, 4718592
    s_add_u32 s25, s24, 49152
    s_lshl_b32 s26, s12, 4
    s_add_u32 s26, s26, s7
    s_lshl_b32 s26, s26, 7
    s_add_u32 s26, s26, 4194304
    v_lshrrev_b32 v1, 2, v0
    v_mul_u32_u24 v1, 3072, v1
    v_and_b32_e64 v2, 3, v0
    v_lshl_add_u32 v1, v2, 4, v1
    v_mul_u32_u24 v2, 3, v0
    v_and_b32 v5, 12, v0
    v_cmp_eq_u32 s[70:71], 0, v5
    v_lshlrev_b32 v7, 4, v0
    v_add_u32 v12, 0, v2
    v_and_b32_e64 v13, 3, v12
    v_and_b32 v12, 0xfc, v12
    v_lshl_add_u32 v3, v13, 6, v12
    v_add_u32 v12, 1, v2
    v_and_b32 v13, 3, v12
    v_and_b32 v12, 0xfc, v12
    v_lshl_add_u32 v4, v13, 6, v12
    v_add_u32 v12, 2, v2
    v_and_b32 v13, 3, v12
    v_and_b32 v12, 0xfc, v12
    v_lshl_add_u32 v5, v13, 6, v12
    v_writelane_b32 v5, 24, 5
    buffer_load_dword v14, off, s[56:59], s26
    s_add_u32 m0, s14, 16384
    s_mov_b32 s15, 128
    buffer_load_dwordx4 v10, s[48:51], s15 offen lds
    s_add_u32 m0, s14, 20480
    s_mov_b32 s15, 32896
    buffer_load_dwordx4 v10, s[48:51], s15 offen lds
    s_add_u32 m0, s14, 24576
    s_mov_b32 s15, 65664
    buffer_load_dwordx4 v10, s[48:51], s15 offen lds
    s_add_u32 m0, s14, 28672
    s_mov_b32 s15, 98432
    buffer_load_dwordx4 v10, s[48:51], s15 offen lds
    s_add_u32 m0, s14, 73728
    s_mov_b32 s15, 197632
    buffer_load_dwordx4 v11, s[52:55], s15 offen lds
    s_add_u32 m0, s14, 81920
    s_mov_b32 s15, 198656
    buffer_load_dwordx4 v11, s[52:55], s15 offen lds
    s_add_u32 m0, s14, 57344
    s_mov_b32 s15, 196608
    buffer_load_dwordx4 v11, s[52:55], s15 offen lds
    s_add_u32 m0, s14, 77824
    s_mov_b32 s15, 295936
    buffer_load_dwordx4 v11, s[52:55], s15 offen lds
    s_add_u32 m0, s14, 86016
    s_mov_b32 s15, 296960
    buffer_load_dwordx4 v11, s[52:55], s15 offen lds
    s_add_u32 m0, s14, 61440
    s_mov_b32 s15, 294912
    buffer_load_dwordx4 v11, s[52:55], s15 offen lds
    s_waitcnt vmcnt(11)
    s_barrier
    s_add_u32 m0, s14, 32768
    s_mov_b32 s15, 256
    buffer_load_dwordx4 v10, s[48:51], s15 offen lds
    s_add_u32 m0, s14, 36864
    s_mov_b32 s15, 33024
    buffer_load_dwordx4 v10, s[48:51], s15 offen lds
    s_add_u32 m0, s14, 40960
    s_mov_b32 s15, 65792
    buffer_load_dwordx4 v10, s[48:51], s15 offen lds
    s_add_u32 m0, s14, 45056
    s_mov_b32 s15, 98560
    buffer_load_dwordx4 v10, s[48:51], s15 offen lds
    s_add_u32 m0, s14, 90112
    s_mov_b32 s15, 394240
    buffer_load_dwordx4 v11, s[52:55], s15 offen lds
    s_add_u32 m0, s14, 98304
    s_mov_b32 s15, 395264
    buffer_load_dwordx4 v11, s[52:55], s15 offen lds
    s_add_u32 m0, s14, 65536
    s_mov_b32 s15, 393216
    buffer_load_dwordx4 v11, s[52:55], s15 offen lds
    s_add_u32 m0, s14, 94208
    s_mov_b32 s15, 492544
    buffer_load_dwordx4 v11, s[52:55], s15 offen lds
    s_add_u32 m0, s14, 102400
    s_mov_b32 s15, 493568
    buffer_load_dwordx4 v11, s[52:55], s15 offen lds
    s_add_u32 m0, s14, 69632
    s_mov_b32 s15, 491520
    buffer_load_dwordx4 v11, s[52:55], s15 offen lds
    s_waitcnt vmcnt(10)
    s_barrier
    s_add_u32 m0, s14, 0
    s_nop 0
    s_mov_b32 s15, 384
    buffer_load_dwordx4 v10, s[48:51], s15 offen lds
    s_add_u32 m0, s14, 4096
    s_mov_b32 s15, 33152
    buffer_load_dwordx4 v10, s[48:51], s15 offen lds
    s_add_u32 m0, s14, 8192
    s_mov_b32 s15, 65920
    buffer_load_dwordx4 v10, s[48:51], s15 offen lds
    s_add_u32 m0, s14, 12288
    s_mov_b32 s15, 98688
    buffer_load_dwordx4 v10, s[48:51], s15 offen lds
    s_add_u32 m0, s14, 106496
    s_mov_b32 s15, 590848
    buffer_load_dwordx4 v11, s[52:55], s15 offen lds
    s_add_u32 m0, s14, 114688
    s_mov_b32 s15, 591872
    buffer_load_dwordx4 v11, s[52:55], s15 offen lds
    s_add_u32 m0, s14, 49152
    s_mov_b32 s15, 589824
    buffer_load_dwordx4 v11, s[52:55], s15 offen lds
    s_add_u32 m0, s14, 110592
    s_mov_b32 s15, 689152
    buffer_load_dwordx4 v11, s[52:55], s15 offen lds
    s_add_u32 m0, s14, 118784
    s_mov_b32 s15, 690176
    buffer_load_dwordx4 v11, s[52:55], s15 offen lds
    s_add_u32 m0, s14, 53248
    s_mov_b32 s15, 688128
    buffer_load_dwordx4 v11, s[52:55], s15 offen lds
    s_waitcnt vmcnt(10)
    s_barrier
    s_add_u32 m0, s14, 16384
    s_mov_b32 s15, 512
    buffer_load_dwordx4 v10, s[48:51], s15 offen lds
    s_add_u32 m0, s14, 20480
    s_mov_b32 s15, 33280
    buffer_load_dwordx4 v10, s[48:51], s15 offen lds
    s_add_u32 m0, s14, 24576
    s_mov_b32 s15, 66048
    buffer_load_dwordx4 v10, s[48:51], s15 offen lds
    s_add_u32 m0, s14, 28672
    s_mov_b32 s15, 98816
    buffer_load_dwordx4 v10, s[48:51], s15 offen lds
    s_add_u32 m0, s14, 73728
    s_mov_b32 s15, 787456
    buffer_load_dwordx4 v11, s[52:55], s15 offen lds
    s_add_u32 m0, s14, 81920
    s_mov_b32 s15, 788480
    buffer_load_dwordx4 v11, s[52:55], s15 offen lds
    s_add_u32 m0, s14, 57344
    s_mov_b32 s15, 786432
    buffer_load_dwordx4 v11, s[52:55], s15 offen lds
    s_add_u32 m0, s14, 77824
    s_mov_b32 s15, 885760
    buffer_load_dwordx4 v11, s[52:55], s15 offen lds
    s_add_u32 m0, s14, 86016
    s_mov_b32 s15, 886784
    buffer_load_dwordx4 v11, s[52:55], s15 offen lds
    s_add_u32 m0, s14, 61440
    s_mov_b32 s15, 884736
    buffer_load_dwordx4 v11, s[52:55], s15 offen lds
    s_waitcnt vmcnt(10)
    s_barrier
    s_add_u32 m0, s14, 32768
    s_mov_b32 s15, 640
    buffer_load_dwordx4 v10, s[48:51], s15 offen lds
    s_add_u32 m0, s14, 36864
    s_mov_b32 s15, 33408
    buffer_load_dwordx4 v10, s[48:51], s15 offen lds
    s_add_u32 m0, s14, 40960
    s_mov_b32 s15, 66176
    buffer_load_dwordx4 v10, s[48:51], s15 offen lds
    s_add_u32 m0, s14, 45056
    s_mov_b32 s15, 98944
    buffer_load_dwordx4 v10, s[48:51], s15 offen lds
    s_add_u32 m0, s14, 90112
    s_mov_b32 s15, 984064
    buffer_load_dwordx4 v11, s[52:55], s15 offen lds
    s_add_u32 m0, s14, 98304
    s_mov_b32 s15, 985088
    buffer_load_dwordx4 v11, s[52:55], s15 offen lds
    s_add_u32 m0, s14, 94208
    s_mov_b32 s15, 1082368
    buffer_load_dwordx4 v11, s[52:55], s15 offen lds
    s_add_u32 m0, s14, 102400
    s_mov_b32 s15, 1083392
    buffer_load_dwordx4 v11, s[52:55], s15 offen lds
    s_waitcnt vmcnt(8)
    s_barrier
    s_add_u32 m0, s14, 0
    s_nop 0
    s_mov_b32 s15, 768
    buffer_load_dwordx4 v10, s[48:51], s15 offen lds
    s_add_u32 m0, s14, 4096
    s_mov_b32 s15, 33536
    buffer_load_dwordx4 v10, s[48:51], s15 offen lds
    s_add_u32 m0, s14, 8192
    s_mov_b32 s15, 66304
    buffer_load_dwordx4 v10, s[48:51], s15 offen lds
    s_add_u32 m0, s14, 12288
    s_mov_b32 s15, 99072
    buffer_load_dwordx4 v10, s[48:51], s15 offen lds
    s_add_u32 m0, s14, 106496
    s_mov_b32 s15, 1180672
    buffer_load_dwordx4 v11, s[52:55], s15 offen lds
    s_add_u32 m0, s14, 114688
    s_mov_b32 s15, 1181696
    buffer_load_dwordx4 v11, s[52:55], s15 offen lds
    s_add_u32 m0, s14, 110592
    s_mov_b32 s15, 1278976
    buffer_load_dwordx4 v11, s[52:55], s15 offen lds
    s_add_u32 m0, s14, 118784
    s_mov_b32 s15, 1280000
    buffer_load_dwordx4 v11, s[52:55], s15 offen lds
    buffer_load_dwordx2 v[18:19], off, s[60:63], 0 sc1
    s_waitcnt vmcnt(9)
    s_barrier
    s_add_u32 m0, s14, 16384
    s_mov_b32 s15, 896
    buffer_load_dwordx4 v10, s[48:51], s15 offen lds
    s_add_u32 m0, s14, 20480
    s_mov_b32 s15, 33664
    buffer_load_dwordx4 v10, s[48:51], s15 offen lds
    s_add_u32 m0, s14, 24576
    s_mov_b32 s15, 66432
    buffer_load_dwordx4 v10, s[48:51], s15 offen lds
    s_add_u32 m0, s14, 28672
    s_mov_b32 s15, 99200
    buffer_load_dwordx4 v10, s[48:51], s15 offen lds
    s_add_u32 m0, s14, 73728
    s_mov_b32 s15, 1377280
    buffer_load_dwordx4 v11, s[52:55], s15 offen lds
    s_add_u32 m0, s14, 81920
    s_mov_b32 s15, 1378304
    buffer_load_dwordx4 v11, s[52:55], s15 offen lds
    s_add_u32 m0, s14, 77824
    s_mov_b32 s15, 1475584
    buffer_load_dwordx4 v11, s[52:55], s15 offen lds
    s_add_u32 m0, s14, 86016
    s_mov_b32 s15, 1476608
    buffer_load_dwordx4 v11, s[52:55], s15 offen lds
    s_waitcnt vmcnt(8)
    s_barrier
    s_add_u32 m0, s14, 65536
    s_mov_b32 s15, 983040
    buffer_load_dwordx4 v11, s[52:55], s15 offen lds
    s_add_u32 m0, s14, 49152
    s_mov_b32 s15, 1179648
    buffer_load_dwordx4 v11, s[52:55], s15 offen lds
    s_add_u32 m0, s14, 57344
    s_mov_b32 s15, 1376256
    buffer_load_dwordx4 v11, s[52:55], s15 offen lds
    s_add_u32 m0, s14, 69632
    s_mov_b32 s15, 1081344
    buffer_load_dwordx4 v11, s[52:55], s15 offen lds
    s_add_u32 m0, s14, 53248
    s_mov_b32 s15, 1277952
    buffer_load_dwordx4 v11, s[52:55], s15 offen lds
    s_add_u32 m0, s14, 61440
    s_mov_b32 s15, 1474560
    buffer_load_dwordx4 v11, s[52:55], s15 offen lds
    v_cmp_eq_u32_e64 vcc, 0, v19
    s_nop 1
    s_cbranch_vccz L_g_non_done
    s_mov_b32 s72, 65536
L_g_non:
    buffer_load_dwordx2 v[18:19], off, s[60:63], 0 sc1
    s_sub_u32 s72, s72, 1
    s_waitcnt vmcnt(0)
    v_cmp_eq_u32 vcc, 0, v19
    s_cmp_eq_u32 s72, 0
    s_cbranch_scc1 L_g_non_done
    s_cbranch_vccz L_g_non_done
    s_sleep 4
    s_branch L_g_non
L_g_non_done:
    v_mov_b32 v16, 0
    v_mov_b32 v17, 0
    v_mov_b32 v15, 98240
    ds_write_b128 v15, v[16:19]
    ds_write_b32 v15, v16 offset:16
    s_waitcnt vmcnt(6)
    s_waitcnt lgkmcnt(0)
    s_barrier
    s_lshl_b32 s64, s7, 3
    s_add_u32 s64, s64, s8
    s_lshl_b32 s64, s64, 2
    s_add_u32 s64, s64, s10
    s_lshl_b32 s67, s64, 4
    s_add_u32 s67, s67, 4259840
    s_lshl_b32 s64, s64, 12
    s_nop 0
    global_load_dwordx4 v[48:51], v7, s[40:41]
    buffer_load_dwordx4 v[52:55], v7, s[48:51], s64 offen offset:0
    buffer_load_dwordx4 v[56:59], v7, s[48:51], s64 offen offset:1024
    buffer_load_dwordx4 v[60:63], v7, s[48:51], s64 offen offset:2048
    buffer_load_dwordx4 v[64:67], v7, s[48:51], s64 offen offset:3072
    s_mov_b32 s52, s20
    s_mov_b32 s53, s21
    s_mov_b32 s54, 524288
    s_mov_b32 s55, 0x20000
    v_lshrrev_b32 v22, 3, v0
    v_and_b32 v23, 7, v0
    v_bfe_u32 v24, v0, 4, 1
    v_lshlrev_b32 v24, 2, v24
    v_xor_b32 v24, v24, v23
    v_lshlrev_b32_e64 v22, 10, v22
    v_lshl_add_u32 v22, v24, 4, v22
    s_lshl_b32 s64, s10, 13
    s_lshr_b32 s65, s2, 5
    s_lshl_b32 s65, s65, 7
    s_add_u32 s64, s64, s65
    v_add_u32_e64 v22, s64, v22
    s_lshl_b32 s64, s10, 10
    s_add_u32 s64, s64, s0
    s_add_u32 m0, s64, 0
    s_mov_b32 s65, 0
    buffer_load_dwordx4 v22, s[52:55], s65 offen lds
    s_add_u32 m0, s64, 4096
    s_mov_b32 s65, 32768
    buffer_load_dwordx4 v22, s[52:55], s65 offen lds
    s_waitcnt vmcnt(7)
    s_barrier
    s_add_u32 m0, s64, 8192
    s_mov_b32 s65, 65536
    buffer_load_dwordx4 v22, s[52:55], s65 offen lds
    s_add_u32 m0, s64, 12288
    s_mov_b32 s65, 98304
    buffer_load_dwordx4 v22, s[52:55], s65 offen lds
    s_add_u32 s64, s64, s1
    s_add_u32 m0, s64, 0
    s_mov_b32 s65, 131072
    buffer_load_dwordx4 v22, s[52:55], s65 offen lds
    s_add_u32 m0, s64, 4096
    s_mov_b32 s65, 163840
    buffer_load_dwordx4 v22, s[52:55], s65 offen lds
    s_add_u32 m0, s64, 8192
    s_mov_b32 s65, 196608
    buffer_load_dwordx4 v22, s[52:55], s65 offen lds
    s_add_u32 m0, s64, 12288
    s_mov_b32 s65, 229376
    buffer_load_dwordx4 v22, s[52:55], s65 offen lds
    s_add_u32 s64, s64, s1
    s_add_u32 m0, s64, 0
    s_mov_b32 s65, 262144
    buffer_load_dwordx4 v22, s[52:55], s65 offen lds
    s_add_u32 m0, s64, 4096
    s_mov_b32 s65, 294912
    buffer_load_dwordx4 v22, s[52:55], s65 offen lds
    s_add_u32 m0, s64, 8192
    s_mov_b32 s65, 327680
    buffer_load_dwordx4 v22, s[52:55], s65 offen lds
    s_add_u32 m0, s64, 12288
    s_mov_b32 s65, 360448
    buffer_load_dwordx4 v22, s[52:55], s65 offen lds
    s_add_u32 s64, s64, s1
    s_add_u32 m0, s64, 0
    s_mov_b32 s65, 393216
    buffer_load_dwordx4 v22, s[52:55], s65 offen lds
    s_add_u32 m0, s64, 4096
    s_mov_b32 s65, 425984
    buffer_load_dwordx4 v22, s[52:55], s65 offen lds
    s_add_u32 m0, s64, 8192
    s_mov_b32 s65, 458752
    buffer_load_dwordx4 v22, s[52:55], s65 offen lds
    s_add_u32 m0, s64, 12288
    s_mov_b32 s65, 491520
    buffer_load_dwordx4 v22, s[52:55], s65 offen lds
    s_waitcnt vmcnt(16)
    s_nop 0
    v_dot2_f32_bf16 v44, v52, v48, 0
    v_dot2_f32_bf16 v45, v56, v48, 0
    v_dot2_f32_bf16 v46, v60, v48, 0
    v_dot2_f32_bf16 v47, v64, v48, 0
    v_dot2_f32_bf16 v44, v53, v49, v44
    v_dot2_f32_bf16 v45, v57, v49, v45
    v_dot2_f32_bf16 v46, v61, v49, v46
    v_dot2_f32_bf16 v47, v65, v49, v47
    v_dot2_f32_bf16 v44, v54, v50, v44
    v_dot2_f32_bf16 v45, v58, v50, v45
    v_dot2_f32_bf16 v46, v62, v50, v46
    v_dot2_f32_bf16 v47, v66, v50, v47
    v_dot2_f32_bf16 v44, v55, v51, v44
    v_dot2_f32_bf16 v45, v59, v51, v45
    v_dot2_f32_bf16 v46, v63, v51, v46
    v_dot2_f32_bf16 v47, v67, v51, v47
    s_mov_b32 s65, 3216550459
    v_lshrrev_b32 v69, 2, v0
    s_nop 1
    v_permlane16_swap_b32 v44, v45
    v_permlane16_swap_b32 v46, v47
    v_add_f32 v44, v44, v45
    v_add_f32 v46, v46, v47
    s_nop 1
    v_permlane32_swap_b32 v44, v46
    v_add_f32 v44, v44, v46
    s_nop 1
    v_add_f32_dpp v44, v44, v44 row_ror:1 row_mask:0xf bank_mask:0xf
    s_nop 1
    v_add_f32_dpp v44, v44, v44 row_ror:2 row_mask:0xf bank_mask:0xf
    s_nop 1
    v_add_f32_dpp v44, v44, v44 row_ror:4 row_mask:0xf bank_mask:0xf
    s_nop 1
    v_add_f32_dpp v44, v44, v44 row_ror:8 row_mask:0xf bank_mask:0xf
    v_mul_f32 v44, s65, v44
    v_exp_f32 v44, v44
    s_nop 0
    v_add_f32 v44, 1.0, v44
    v_rcp_f32 v68, v44
    s_mov_b32 exec_lo, 0x00010001
    s_mov_b32 exec_hi, 0x00010001
    buffer_store_dword v68, v69, s[56:59], s67 offen sc1
    s_mov_b64 exec, -1
    s_and_b32 s7, s6, 3
    s_lshl_b32 s8, s4, 2
    s_add_u32 s7, s7, s8
    s_lshr_b32 s8, s6, 2
    v_lshrrev_b32 v76, 3, v0
    v_and_b32 v77, 7, v0
    v_lshlrev_b32 v70, 12, v76
    v_lshl_add_u32 v70, v77, 4, v70
    s_lshl_b32 s13, s8, 18
    s_lshl_b32 s12, s10, 15
    s_add_u32 s13, s13, s12
    s_lshl_b32 s12, s7, 7
    s_add_u32 s13, s13, s12
    s_add_u32 s13, s13, 2097152
    s_add_u32 s14, s13, 131072
    s_lshl_b32 s12, s10, 10
    s_add_u32 s15, s12, s23
    v_lshl_add_u32 v71, v0, 4, s15
    s_lshr_b32 s64, s7, 3
    s_lshl_b32 s64, s64, 2
    s_bfe_u32 s65, s7, 0x10002
    s_add_u32 s64, s64, s65
    s_lshl_b32 s64, s64, 10
    s_add_u32 s11, s64, 4292608
    v_and_b32 v76, 8, v0
    v_lshl_add_u32 v81, v76, 1, v77
    v_lshlrev_b32 v81, 7, v81
    v_and_b32 v76, 1, v0
    v_and_b32_e64 v77, 2, v0
    v_lshl_add_u32 v82, v77, 2, v76
    v_lshlrev_b32 v82, 7, v82
    s_lshl_b32 s67, s8, 11
    s_lshl_b32 s65, s10, 8
    s_add_u32 s67, s67, s65
    s_add_u32 s67, s67, 4308992
    v_mov_b32 v83, s75
    s_mul_i32 s64, s10, s73
    s_add_u32 s64, s64, s22
    v_lshrrev_b32 v76, 5, v0
    v_mul_u32_u24 v76, 544, v76
    v_bfe_u32 v77, v0, 3, 2
    v_and_b32 v78, 7, v0
    v_min_u32 v78, 5, v78
    v_mul_u32_u24_e64 v79, 12, v78
    v_lshl_add_u32 v79, v77, 6, v79
    v_add3_u32 v72, v76, v79, s64
    v_and_b32_e64 v79, 1, v77
    v_mul_u32_u24 v79, 272, v79
    v_lshrrev_b32_e64 v77, 1, v77
    v_lshl_add_u32 v79, v77, 3, v79
    v_add3_u32 v79, v76, v79, s64
    v_add_u32 v79, 252, v79
    v_cmp_eq_u32_e64 vcc, 5, v78
    v_add_u32 v80, -272, v79
    v_lshlrev_b32 v78, 4, v78
    v_cndmask_b32 v73, v72, v79, vcc
    v_cndmask_b32 v74, v72, v80, vcc
    v_lshrrev_b32 v76, 3, v0
    v_lshl_add_u32 v75, v76, 7, v78
    s_lshl_b32 s68, s10, 13
    s_add_u32 s68, s68, 4194304
    s_add_u32 s69, s68, 4096
    s_setprio 2
    s_cmp_ge_u32 s10, 2
    s_cbranch_scc1 L_rs_skip
    s_mov_b32 s72, 262144
L_pub:
    ds_read_b32 v8, v83 offset:16
    s_sub_u32 s72, s72, 1
    s_waitcnt lgkmcnt(0)
    v_readfirstlane_b32 s64, v8
    s_nop 0
    s_cmp_lg_u32 s64, 0
    s_cbranch_scc1 L_pub_done
    s_sleep 1
    s_cmp_lg_u32 s72, 0
    s_cbranch_scc1 L_pub
L_pub_done:
    s_sleep 1
    s_mov_b32 s72, 65536
L_rs:
    buffer_load_dwordx4 v[20:23], v1, s[56:59], s24 offen offset:0 sc1
    buffer_load_dwordx4 v[24:27], v1, s[56:59], s24 offen offset:1024 sc1
    buffer_load_dwordx4 v[28:31], v1, s[56:59], s24 offen offset:2048 sc1
    buffer_load_dwordx4 v[32:35], v1, s[56:59], s25 offen offset:0 sc1
    buffer_load_dwordx4 v[36:39], v1, s[56:59], s25 offen offset:1024 sc1
    buffer_load_dwordx4 v[40:43], v1, s[56:59], s25 offen offset:2048 sc1
    s_sub_u32 s72, s72, 1
    s_waitcnt vmcnt(0)
    v_xor_b32 v8, v23, v18
    v_xor_b32 v9, v27, v18
    v_xor_b32 v10, v31, v18
    v_xor_b32 v11, v35, v18
    v_xor_b32 v12, v39, v18
    v_xor_b32 v13, v43, v18
    v_or3_b32 v8, v8, v9, v10
    v_or3_b32 v11, v11, v12, v13
    v_or_b32 v8, v8, v11
    v_cmp_ne_u32 vcc, 0, v8
    s_cmp_eq_u32 s72, 0
    s_cbranch_scc1 L_rs_done
    s_cbranch_vccz L_rs_done
    s_sleep 1
    s_branch L_rs
L_rs_done:
    v_add_f32 v20, v20, v32
    v_add_f32 v21, v21, v33
    v_add_f32 v22, v22, v34
    v_add_f32 v24, v24, v36
    v_add_f32 v25, v25, v37
    v_add_f32 v26, v26, v38
    v_add_f32 v28, v28, v40
    v_add_f32 v29, v29, v41
    v_add_f32 v30, v30, v42
    v_mov_b32 v31, v30
    v_permlane16_swap_b32 v20, v22
    v_permlane16_swap_b32 v21, v24
    v_permlane16_swap_b32 v25, v28
    v_permlane16_swap_b32 v26, v29
    v_permlane16_swap_b32 v30, v31
    v_add_f32 v20, v20, v22
    v_add_f32 v21, v21, v24
    v_add_f32 v25, v25, v28
    v_add_f32 v26, v26, v29
    v_add_f32 v30, v30, v31
    v_mov_b32 v31, v30
    v_permlane32_swap_b32 v20, v25
    v_permlane32_swap_b32 v21, v26
    v_permlane32_swap_b32 v30, v31
    v_add_f32 v20, v20, v25
    v_add_f32 v21, v21, v26
    v_add_f32 v30, v30, v31
    v_add_f32_dpp v20, v20, v20 row_ror:4 row_mask:0xf bank_mask:0xf
    v_add_f32_dpp v21, v21, v21 row_ror:4 row_mask:0xf bank_mask:0xf
    v_add_f32_dpp v30, v30, v30 row_ror:4 row_mask:0xf bank_mask:0xf
    v_add_f32_dpp v20, v20, v20 row_ror:8 row_mask:0xf bank_mask:0xf
    v_add_f32_dpp v21, v21, v21 row_ror:8 row_mask:0xf bank_mask:0xf
    v_add_f32_dpp v30, v30, v30 row_ror:8 row_mask:0xf bank_mask:0xf
    v_cvt_pk_bf16_f32 v20, v20, v21
    s_nop 0
    v_mov_b32_dpp v31, v30 quad_perm:[1,1,3,3] row_mask:0xf bank_mask:0xf
    v_cvt_pk_bf16_f32 v21, v30, v31
    v_cndmask_b32 v20, v21, v20, s[70:71]
    v_mov_b32 v27, v18
    ds_bpermute_b32 v24, v3, v20
    ds_bpermute_b32 v25, v4, v20
    ds_bpermute_b32 v26, v5, v20
    s_mov_b64 exec, 0x3f
    s_waitcnt lgkmcnt(0)
    buffer_store_dwordx4 v[24:27], v7, s[56:59], s26 offen sc1
    s_mov_b64 exec, -1
    s_barrier
    s_branch L_p2help
L_rs_skip:
    s_waitcnt vmcnt(0)
    s_barrier
    s_cmp_lg_u32 s3, 7
    s_cbranch_scc1 L_p2help
    s_mov_b64 exec, 1
    buffer_store_dwordx2 v[18:19], off, s[56:59], s74 sc1
    s_mov_b64 exec, -1
    s_sleep 2
    s_branch L_p2help
.p2align 3
L_gcomp:
    s_and_b32 s10, s3, 1
    s_lshr_b32 s11, s3, 1
    s_lshl_b32 s15, s8, 1
    s_add_u32 s15, s15, s11
    s_lshl_b32 s13, s7, 1
    s_add_u32 s13, s13, s10
    s_lshl_b32 s12, s15, 5
    s_add_u32 s9, s12, s13
    s_mul_i32 s12, s9, 3072
    s_add_u32 s12, s12, 4718592
    v_lshlrev_b32 v152, 4, v0
    s_waitcnt lgkmcnt(0)
    s_mov_b32 s56, s46
    s_mov_b32 s57, s47
    s_mov_b32 s58, 6291456
    s_mov_b32 s59, 0x20000
    s_mov_b32 s0, 98304
    s_mov_b32 s1, 16384
    s_mov_b32 s22, 73728
    s_mov_b32 s23, 16384
    s_mov_b32 s73, 4352
    s_mov_b32 s75, 98240
    s_lshl_b32 s64, s7, 3
    s_add_u32 s64, s64, s8
    s_lshl_b32 s64, s64, 7
    s_add_u32 s74, s64, 4292608
    buffer_load_dword v254, off, s[56:59], s74
    v_and_b32 v1, 31, v0
    v_lshrrev_b32_e64 v2, 5, v0
    v_bfe_u32 v3, v0, 1, 3
    v_xor_b32 v3, v3, v2
    s_lshl_b32 s64, s10, 13
    v_lshl_add_u32 v4, v1, 7, s64
    v_xor_b32_e64 v5, 0, v3
    v_lshl_add_u32 v144, v5, 4, v4
    v_xor_b32_e64 v5, 2, v3
    v_lshl_add_u32 v145, v5, 4, v4
    v_xor_b32_e64 v5, 4, v3
    v_lshl_add_u32 v146, v5, 4, v4
    v_xor_b32_e64 v5, 6, v3
    v_lshl_add_u32 v147, v5, 4, v4
    v_bfe_u32 v3, v0, 2, 2
    v_lshl_add_u32 v4, v2, 3, v3
    v_lshlrev_b32 v4, 7, v4
    v_and_b32 v5, 3, v0
    v_lshlrev_b32_e64 v5, 3, v5
    v_bfe_u32 v6, v0, 4, 1
    v_cmp_eq_u32 s[66:67], 1, v6
    v_lshl_add_u32 v5, v6, 5, v5
    v_bfe_u32 v6, v0, 3, 1
    v_xor_b32_e64 v6, s11, v6
    v_lshl_add_u32 v5, v6, 6, v5
    v_add_u32_e64 v4, v4, v5
    v_add_u32 v148, 49152, v4
    v_add_u32 v149, 106496, v4
    v_mov_b32 v151, 98240
    s_lshl_b32 s13, s13, 16
    s_lshl_b32 s15, s15, 11
    s_add_u32 s13, s13, s15
    s_add_u32 s15, s13, 32768
    s_mov_b32 s70, 1069066811
    s_mov_b32 s71, 897988541
    v_mov_b32 v1, 897988541
    v_mov_b32 v8, v1
    v_mov_b32 v9, v1
    v_mov_b32 v10, v1
    v_mov_b32 v11, v1
    v_mov_b32 v12, v1
    v_mov_b32 v13, v1
    v_mov_b32 v14, v1
    v_mov_b32 v15, v1
    v_mov_b32 v16, v1
    v_mov_b32 v17, v1
    v_mov_b32 v18, v1
    v_mov_b32 v19, v1
    v_mov_b32 v20, v1
    v_mov_b32 v21, v1
    v_mov_b32 v22, v1
    v_mov_b32 v23, v1
    v_mov_b32 v24, v1
    v_mov_b32 v25, v1
    v_mov_b32 v26, v1
    v_mov_b32 v27, v1
    v_mov_b32 v28, v1
    v_mov_b32 v29, v1
    v_mov_b32 v30, v1
    v_mov_b32 v31, v1
    v_mov_b32 v32, v1
    v_mov_b32 v33, v1
    v_mov_b32 v34, v1
    v_mov_b32 v35, v1
    v_mov_b32 v36, v1
    v_mov_b32 v37, v1
    v_mov_b32 v38, v1
    v_mov_b32 v39, v1
    v_mov_b32 v40, v1
    v_mov_b32 v41, v1
    v_mov_b32 v42, v1
    v_mov_b32 v43, v1
    v_mov_b32 v44, v1
    v_mov_b32 v45, v1
    v_mov_b32 v46, v1
    v_mov_b32 v47, v1
    v_mov_b32 v48, v1
    v_mov_b32 v49, v1
    v_mov_b32 v50, v1
    v_mov_b32 v51, v1
    v_mov_b32 v52, v1
    v_mov_b32 v53, v1
    v_mov_b32 v54, v1
    v_mov_b32 v55, v1
    v_mov_b32 v56, v1
    v_mov_b32 v57, v1
    v_mov_b32 v58, v1
    v_mov_b32 v59, v1
    v_mov_b32 v60, v1
    v_mov_b32 v61, v1
    v_mov_b32 v62, v1
    v_mov_b32 v63, v1
    v_mov_b32 v64, v1
    v_mov_b32 v65, v1
    v_mov_b32 v66, v1
    v_mov_b32 v67, v1
    v_mov_b32 v68, v1
    v_mov_b32 v69, v1
    v_mov_b32 v70, v1
    v_mov_b32_e64 v71, v1
    s_waitcnt vmcnt(0)
    s_barrier
    ds_read_b128 v[104:107], v144 offset:0
    ds_read_b64_tr_b16 v[116:117], v149 offset:0
    ds_read_b64_tr_b16 v[118:119], v149 offset:512
    ds_read_b128 v[108:111], v144 offset:4096
    ds_read_b64_tr_b16 v[120:121], v149 offset:8192
    ds_read_b64_tr_b16 v[122:123], v149 offset:8704
    ds_read_b64_tr_b16 v[112:113], v148 offset:0
    ds_read_b64_tr_b16 v[114:115], v148 offset:512
    s_waitcnt lgkmcnt(0)
    s_nop 0
    v_mfma_f32_32x32x16_bf16 v[40:55], v[104:107], v[116:119], v[40:55]
    ds_read_b128 v[124:127], v145 offset:0
    ds_read_b64_tr_b16 v[136:137], v149 offset:2048
    v_mfma_f32_32x32x16_bf16 v[56:71], v[108:111], v[116:119], v[56:71]
    ds_read_b64_tr_b16 v[138:139], v149 offset:2560
    ds_read_b128 v[128:131], v145 offset:4096
    v_mfma_f32_32x32x16_bf16 v[72:87], v[104:107], v[120:123], 0
    ds_read_b64_tr_b16 v[140:141], v149 offset:10240
    ds_read_b64_tr_b16 v[142:143], v149 offset:10752
    v_mfma_f32_32x32x16_bf16 v[88:103], v[108:111], v[120:123], 0
    ds_read_b64_tr_b16 v[132:133], v148 offset:2048
    ds_read_b64_tr_b16 v[134:135], v148 offset:2560
    v_mfma_f32_32x32x16_bf16 v[8:23], v[112:115], v[104:107], v[8:23]
    v_mfma_f32_32x32x16_bf16 v[24:39], v[112:115], v[108:111], v[24:39]
    s_waitcnt lgkmcnt(0)
    s_nop 0
    v_mfma_f32_32x32x16_bf16 v[40:55], v[124:127], v[136:139], v[40:55]
    ds_read_b128 v[104:107], v146 offset:0
    ds_read_b64_tr_b16 v[116:117], v149 offset:4096
    v_mfma_f32_32x32x16_bf16 v[56:71], v[128:131], v[136:139], v[56:71]
    ds_read_b64_tr_b16 v[118:119], v149 offset:4608
    ds_read_b128 v[108:111], v146 offset:4096
    v_mfma_f32_32x32x16_bf16 v[72:87], v[124:127], v[140:143], v[72:87]
    ds_read_b64_tr_b16 v[120:121], v149 offset:12288
    ds_read_b64_tr_b16 v[122:123], v149 offset:12800
    v_mfma_f32_32x32x16_bf16 v[88:103], v[128:131], v[140:143], v[88:103]
    ds_read_b64_tr_b16 v[112:113], v148 offset:4096
    ds_read_b64_tr_b16 v[114:115], v148 offset:4608
    v_mfma_f32_32x32x16_bf16 v[8:23], v[132:135], v[124:127], v[8:23]
    v_mfma_f32_32x32x16_bf16 v[24:39], v[132:135], v[128:131], v[24:39]
    s_waitcnt lgkmcnt(0)
    s_nop 0
    v_mfma_f32_32x32x16_bf16 v[40:55], v[104:107], v[116:119], v[40:55]
    ds_read_b128 v[124:127], v147 offset:0
    ds_read_b64_tr_b16 v[136:137], v149 offset:6144
    v_mfma_f32_32x32x16_bf16 v[56:71], v[108:111], v[116:119], v[56:71]
    ds_read_b64_tr_b16 v[138:139], v149 offset:6656
    ds_read_b128 v[128:131], v147 offset:4096
    v_mfma_f32_32x32x16_bf16 v[72:87], v[104:107], v[120:123], v[72:87]
    ds_read_b64_tr_b16 v[140:141], v149 offset:14336
    ds_read_b64_tr_b16 v[142:143], v149 offset:14848
    v_mfma_f32_32x32x16_bf16 v[88:103], v[108:111], v[120:123], v[88:103]
    ds_read_b64_tr_b16 v[132:133], v148 offset:6144
    ds_read_b64_tr_b16 v[134:135], v148 offset:6656
    v_mfma_f32_32x32x16_bf16 v[8:23], v[112:115], v[104:107], v[8:23]
    v_mfma_f32_32x32x16_bf16 v[24:39], v[112:115], v[108:111], v[24:39]
    s_waitcnt lgkmcnt(0)
    v_mfma_f32_32x32x16_bf16 v[40:55], v[124:127], v[136:139], v[40:55]
    s_barrier
    v_mfma_f32_32x32x16_bf16 v[56:71], v[128:131], v[136:139], v[56:71]
    ds_read_b128 v[104:107], v144 offset:16384
    ds_read_b64_tr_b16 v[116:117], v148 offset:24576
    ds_read_b64_tr_b16 v[118:119], v148 offset:25088
    v_mfma_f32_32x32x16_bf16 v[72:87], v[124:127], v[140:143], v[72:87]
    ds_read_b128 v[108:111], v144 offset:20480
    ds_read_b64_tr_b16 v[120:121], v148 offset:32768
    ds_read_b64_tr_b16 v[122:123], v148 offset:33280
    v_mfma_f32_32x32x16_bf16 v[88:103], v[128:131], v[140:143], v[88:103]
    ds_read_b64_tr_b16 v[112:113], v148 offset:8192
    ds_read_b64_tr_b16 v[114:115], v148 offset:8704
    v_mfma_f32_32x32x16_bf16 v[8:23], v[132:135], v[124:127], v[8:23]
    v_mfma_f32_32x32x16_bf16 v[24:39], v[132:135], v[128:131], v[24:39]
    s_waitcnt lgkmcnt(0)
    s_nop 0
    v_mfma_f32_32x32x16_bf16 v[40:55], v[104:107], v[116:119], v[40:55]
    ds_read_b128 v[124:127], v145 offset:16384
    ds_read_b64_tr_b16 v[136:137], v148 offset:26624
    v_mfma_f32_32x32x16_bf16 v[56:71], v[108:111], v[116:119], v[56:71]
    ds_read_b64_tr_b16 v[138:139], v148 offset:27136
    ds_read_b128 v[128:131], v145 offset:20480
    v_mfma_f32_32x32x16_bf16 v[72:87], v[104:107], v[120:123], v[72:87]
    ds_read_b64_tr_b16 v[140:141], v148 offset:34816
    ds_read_b64_tr_b16 v[142:143], v148 offset:35328
    v_mfma_f32_32x32x16_bf16 v[88:103], v[108:111], v[120:123], v[88:103]
    ds_read_b64_tr_b16 v[132:133], v148 offset:10240
    ds_read_b64_tr_b16 v[134:135], v148 offset:10752
    v_mfma_f32_32x32x16_bf16 v[8:23], v[112:115], v[104:107], v[8:23]
    v_mfma_f32_32x32x16_bf16 v[24:39], v[112:115], v[108:111], v[24:39]
    s_waitcnt lgkmcnt(0)
    s_nop 0
    v_mfma_f32_32x32x16_bf16 v[40:55], v[124:127], v[136:139], v[40:55]
    ds_read_b128 v[104:107], v146 offset:16384
    ds_read_b64_tr_b16 v[116:117], v148 offset:28672
    v_mfma_f32_32x32x16_bf16 v[56:71], v[128:131], v[136:139], v[56:71]
    ds_read_b64_tr_b16 v[118:119], v148 offset:29184
    ds_read_b128 v[108:111], v146 offset:20480
    v_mfma_f32_32x32x16_bf16 v[72:87], v[124:127], v[140:143], v[72:87]
    ds_read_b64_tr_b16 v[120:121], v148 offset:36864
    ds_read_b64_tr_b16 v[122:123], v148 offset:37376
    v_mfma_f32_32x32x16_bf16 v[88:103], v[128:131], v[140:143], v[88:103]
    ds_read_b64_tr_b16 v[112:113], v148 offset:12288
    ds_read_b64_tr_b16 v[114:115], v148 offset:12800
    v_mfma_f32_32x32x16_bf16 v[8:23], v[132:135], v[124:127], v[8:23]
    v_mfma_f32_32x32x16_bf16 v[24:39], v[132:135], v[128:131], v[24:39]
    s_waitcnt lgkmcnt(0)
    s_nop 0
    v_mfma_f32_32x32x16_bf16 v[40:55], v[104:107], v[116:119], v[40:55]
    ds_read_b128 v[124:127], v147 offset:16384
    ds_read_b64_tr_b16 v[136:137], v148 offset:30720
    v_mfma_f32_32x32x16_bf16 v[56:71], v[108:111], v[116:119], v[56:71]
    ds_read_b64_tr_b16 v[138:139], v148 offset:31232
    ds_read_b128 v[128:131], v147 offset:20480
    v_mfma_f32_32x32x16_bf16 v[72:87], v[104:107], v[120:123], v[72:87]
    ds_read_b64_tr_b16 v[140:141], v148 offset:38912
    ds_read_b64_tr_b16 v[142:143], v148 offset:39424
    v_mfma_f32_32x32x16_bf16 v[88:103], v[108:111], v[120:123], v[88:103]
    ds_read_b64_tr_b16 v[132:133], v148 offset:14336
    ds_read_b64_tr_b16 v[134:135], v148 offset:14848
    v_mfma_f32_32x32x16_bf16 v[8:23], v[112:115], v[104:107], v[8:23]
    v_mfma_f32_32x32x16_bf16 v[24:39], v[112:115], v[108:111], v[24:39]
    s_waitcnt lgkmcnt(0)
    v_mfma_f32_32x32x16_bf16 v[40:55], v[124:127], v[136:139], v[40:55]
    s_barrier
    v_mfma_f32_32x32x16_bf16 v[56:71], v[128:131], v[136:139], v[56:71]
    ds_read_b128 v[104:107], v144 offset:32768
    ds_read_b64_tr_b16 v[116:117], v148 offset:40960
    ds_read_b64_tr_b16 v[118:119], v148 offset:41472
    v_mfma_f32_32x32x16_bf16 v[72:87], v[124:127], v[140:143], v[72:87]
    ds_read_b128 v[108:111], v144 offset:36864
    ds_read_b64_tr_b16 v[120:121], v148 offset:49152
    ds_read_b64_tr_b16 v[122:123], v148 offset:49664
    v_mfma_f32_32x32x16_bf16 v[88:103], v[128:131], v[140:143], v[88:103]
    ds_read_b64_tr_b16 v[112:113], v148 offset:16384
    ds_read_b64_tr_b16 v[114:115], v148 offset:16896
    v_mfma_f32_32x32x16_bf16 v[8:23], v[132:135], v[124:127], v[8:23]
    v_mfma_f32_32x32x16_bf16 v[24:39], v[132:135], v[128:131], v[24:39]
    s_waitcnt lgkmcnt(0)
    s_nop 0
    v_mfma_f32_32x32x16_bf16 v[40:55], v[104:107], v[116:119], v[40:55]
    ds_read_b128 v[124:127], v145 offset:32768
    ds_read_b64_tr_b16 v[136:137], v148 offset:43008
    v_mfma_f32_32x32x16_bf16 v[56:71], v[108:111], v[116:119], v[56:71]
    ds_read_b64_tr_b16 v[138:139], v148 offset:43520
    ds_read_b128 v[128:131], v145 offset:36864
    v_mfma_f32_32x32x16_bf16 v[72:87], v[104:107], v[120:123], v[72:87]
    ds_read_b64_tr_b16 v[140:141], v148 offset:51200
    ds_read_b64_tr_b16 v[142:143], v148 offset:51712
    v_mfma_f32_32x32x16_bf16 v[88:103], v[108:111], v[120:123], v[88:103]
    ds_read_b64_tr_b16 v[132:133], v148 offset:18432
    ds_read_b64_tr_b16 v[134:135], v148 offset:18944
    v_mfma_f32_32x32x16_bf16 v[8:23], v[112:115], v[104:107], v[8:23]
    v_mfma_f32_32x32x16_bf16 v[24:39], v[112:115], v[108:111], v[24:39]
    s_waitcnt lgkmcnt(0)
    s_nop 0
    v_mfma_f32_32x32x16_bf16 v[40:55], v[124:127], v[136:139], v[40:55]
    ds_read_b128 v[104:107], v146 offset:32768
    ds_read_b64_tr_b16 v[116:117], v148 offset:45056
    v_mfma_f32_32x32x16_bf16 v[56:71], v[128:131], v[136:139], v[56:71]
    ds_read_b64_tr_b16 v[118:119], v148 offset:45568
    ds_read_b128 v[108:111], v146 offset:36864
    v_mfma_f32_32x32x16_bf16 v[72:87], v[124:127], v[140:143], v[72:87]
    ds_read_b64_tr_b16 v[120:121], v148 offset:53248
    ds_read_b64_tr_b16 v[122:123], v148 offset:53760
    v_mfma_f32_32x32x16_bf16 v[88:103], v[128:131], v[140:143], v[88:103]
    ds_read_b64_tr_b16 v[112:113], v148 offset:20480
    ds_read_b64_tr_b16 v[114:115], v148 offset:20992
    v_mfma_f32_32x32x16_bf16 v[8:23], v[132:135], v[124:127], v[8:23]
    v_mfma_f32_32x32x16_bf16 v[24:39], v[132:135], v[128:131], v[24:39]
    s_waitcnt lgkmcnt(0)
    s_nop 0
    v_mfma_f32_32x32x16_bf16 v[40:55], v[104:107], v[116:119], v[40:55]
    ds_read_b128 v[124:127], v147 offset:32768
    ds_read_b64_tr_b16 v[136:137], v148 offset:47104
    v_mfma_f32_32x32x16_bf16 v[56:71], v[108:111], v[116:119], v[56:71]
    ds_read_b64_tr_b16 v[138:139], v148 offset:47616
    ds_read_b128 v[128:131], v147 offset:36864
    v_mfma_f32_32x32x16_bf16 v[72:87], v[104:107], v[120:123], v[72:87]
    ds_read_b64_tr_b16 v[140:141], v148 offset:55296
    ds_read_b64_tr_b16 v[142:143], v148 offset:55808
    v_mfma_f32_32x32x16_bf16 v[88:103], v[108:111], v[120:123], v[88:103]
    ds_read_b64_tr_b16 v[132:133], v148 offset:22528
    ds_read_b64_tr_b16 v[134:135], v148 offset:23040
    v_mfma_f32_32x32x16_bf16 v[8:23], v[112:115], v[104:107], v[8:23]
    v_mfma_f32_32x32x16_bf16 v[24:39], v[112:115], v[108:111], v[24:39]
    s_waitcnt lgkmcnt(0)
    v_mfma_f32_32x32x16_bf16 v[40:55], v[124:127], v[136:139], v[40:55]
    s_barrier
    v_mfma_f32_32x32x16_bf16 v[56:71], v[128:131], v[136:139], v[56:71]
    ds_read_b128 v[104:107], v144 offset:0
    ds_read_b64_tr_b16 v[116:117], v149 offset:0
    ds_read_b64_tr_b16 v[118:119], v149 offset:512
    v_mfma_f32_32x32x16_bf16 v[72:87], v[124:127], v[140:143], v[72:87]
    ds_read_b128 v[108:111], v144 offset:4096
    ds_read_b64_tr_b16 v[120:121], v149 offset:8192
    ds_read_b64_tr_b16 v[122:123], v149 offset:8704
    v_mfma_f32_32x32x16_bf16 v[88:103], v[128:131], v[140:143], v[88:103]
    ds_read_b64_tr_b16 v[112:113], v148 offset:0
    ds_read_b64_tr_b16 v[114:115], v148 offset:512
    v_mfma_f32_32x32x16_bf16 v[8:23], v[132:135], v[124:127], v[8:23]
    v_mfma_f32_32x32x16_bf16 v[24:39], v[132:135], v[128:131], v[24:39]
    s_waitcnt lgkmcnt(0)
    s_nop 0
    v_mfma_f32_32x32x16_bf16 v[40:55], v[104:107], v[116:119], v[40:55]
    ds_read_b128 v[124:127], v145 offset:0
    ds_read_b64_tr_b16 v[136:137], v149 offset:2048
    v_mfma_f32_32x32x16_bf16 v[56:71], v[108:111], v[116:119], v[56:71]
    ds_read_b64_tr_b16 v[138:139], v149 offset:2560
    ds_read_b128 v[128:131], v145 offset:4096
    v_mfma_f32_32x32x16_bf16 v[72:87], v[104:107], v[120:123], v[72:87]
    ds_read_b64_tr_b16 v[140:141], v149 offset:10240
    ds_read_b64_tr_b16 v[142:143], v149 offset:10752
    v_mfma_f32_32x32x16_bf16 v[88:103], v[108:111], v[120:123], v[88:103]
    ds_read_b64_tr_b16 v[132:133], v148 offset:2048
    ds_read_b64_tr_b16 v[134:135], v148 offset:2560
    v_mfma_f32_32x32x16_bf16 v[8:23], v[112:115], v[104:107], v[8:23]
    v_mfma_f32_32x32x16_bf16 v[24:39], v[112:115], v[108:111], v[24:39]
    s_waitcnt lgkmcnt(0)
    s_nop 0
    v_mfma_f32_32x32x16_bf16 v[40:55], v[124:127], v[136:139], v[40:55]
    ds_read_b128 v[104:107], v146 offset:0
    ds_read_b64_tr_b16 v[116:117], v149 offset:4096
    v_mfma_f32_32x32x16_bf16 v[56:71], v[128:131], v[136:139], v[56:71]
    ds_read_b64_tr_b16 v[118:119], v149 offset:4608
    ds_read_b128 v[108:111], v146 offset:4096
    v_mfma_f32_32x32x16_bf16 v[72:87], v[124:127], v[140:143], v[72:87]
    ds_read_b64_tr_b16 v[120:121], v149 offset:12288
    ds_read_b64_tr_b16 v[122:123], v149 offset:12800
    v_mfma_f32_32x32x16_bf16 v[88:103], v[128:131], v[140:143], v[88:103]
    ds_read_b64_tr_b16 v[112:113], v148 offset:4096
    ds_read_b64_tr_b16 v[114:115], v148 offset:4608
    v_mfma_f32_32x32x16_bf16 v[8:23], v[132:135], v[124:127], v[8:23]
    v_mfma_f32_32x32x16_bf16 v[24:39], v[132:135], v[128:131], v[24:39]
    s_waitcnt lgkmcnt(0)
    s_nop 0
    v_mfma_f32_32x32x16_bf16 v[40:55], v[104:107], v[116:119], v[40:55]
    ds_read_b128 v[124:127], v147 offset:0
    ds_read_b64_tr_b16 v[136:137], v149 offset:6144
    v_mfma_f32_32x32x16_bf16 v[56:71], v[108:111], v[116:119], v[56:71]
    ds_read_b64_tr_b16 v[138:139], v149 offset:6656
    ds_read_b128 v[128:131], v147 offset:4096
    v_mfma_f32_32x32x16_bf16 v[72:87], v[104:107], v[120:123], v[72:87]
    ds_read_b64_tr_b16 v[140:141], v149 offset:14336
    ds_read_b64_tr_b16 v[142:143], v149 offset:14848
    v_mfma_f32_32x32x16_bf16 v[88:103], v[108:111], v[120:123], v[88:103]
    ds_read_b64_tr_b16 v[132:133], v148 offset:6144
    ds_read_b64_tr_b16 v[134:135], v148 offset:6656
    v_mfma_f32_32x32x16_bf16 v[8:23], v[112:115], v[104:107], v[8:23]
    v_mfma_f32_32x32x16_bf16 v[24:39], v[112:115], v[108:111], v[24:39]
    s_waitcnt lgkmcnt(0)
    v_mfma_f32_32x32x16_bf16 v[40:55], v[124:127], v[136:139], v[40:55]
    s_barrier
    v_mfma_f32_32x32x16_bf16 v[56:71], v[128:131], v[136:139], v[56:71]
    ds_read_b128 v[104:107], v144 offset:16384
    ds_read_b64_tr_b16 v[116:117], v148 offset:24576
    ds_read_b64_tr_b16 v[118:119], v148 offset:25088
    v_mfma_f32_32x32x16_bf16 v[72:87], v[124:127], v[140:143], v[72:87]
    ds_read_b128 v[108:111], v144 offset:20480
    ds_read_b64_tr_b16 v[120:121], v148 offset:32768
    ds_read_b64_tr_b16 v[122:123], v148 offset:33280
    v_mfma_f32_32x32x16_bf16 v[88:103], v[128:131], v[140:143], v[88:103]
    ds_read_b64_tr_b16 v[112:113], v148 offset:8192
    ds_read_b64_tr_b16 v[114:115], v148 offset:8704
    v_mfma_f32_32x32x16_bf16 v[8:23], v[132:135], v[124:127], v[8:23]
    v_mfma_f32_32x32x16_bf16 v[24:39], v[132:135], v[128:131], v[24:39]
    s_waitcnt lgkmcnt(0)
    s_nop 0
    v_mfma_f32_32x32x16_bf16 v[40:55], v[104:107], v[116:119], v[40:55]
    ds_read_b128 v[124:127], v145 offset:16384
    ds_read_b64_tr_b16 v[136:137], v148 offset:26624
    v_mfma_f32_32x32x16_bf16 v[56:71], v[108:111], v[116:119], v[56:71]
    ds_read_b64_tr_b16 v[138:139], v148 offset:27136
    ds_read_b128 v[128:131], v145 offset:20480
    v_mfma_f32_32x32x16_bf16 v[72:87], v[104:107], v[120:123], v[72:87]
    ds_read_b64_tr_b16 v[140:141], v148 offset:34816
    ds_read_b64_tr_b16 v[142:143], v148 offset:35328
    v_mfma_f32_32x32x16_bf16 v[88:103], v[108:111], v[120:123], v[88:103]
    ds_read_b64_tr_b16 v[132:133], v148 offset:10240
    ds_read_b64_tr_b16 v[134:135], v148 offset:10752
    v_mfma_f32_32x32x16_bf16 v[8:23], v[112:115], v[104:107], v[8:23]
    v_mfma_f32_32x32x16_bf16 v[24:39], v[112:115], v[108:111], v[24:39]
    s_waitcnt lgkmcnt(0)
    s_nop 0
    v_mfma_f32_32x32x16_bf16 v[40:55], v[124:127], v[136:139], v[40:55]
    ds_read_b128 v[104:107], v146 offset:16384
    ds_read_b64_tr_b16 v[116:117], v148 offset:28672
    v_mfma_f32_32x32x16_bf16 v[56:71], v[128:131], v[136:139], v[56:71]
    ds_read_b64_tr_b16 v[118:119], v148 offset:29184
    ds_read_b128 v[108:111], v146 offset:20480
    v_mfma_f32_32x32x16_bf16 v[72:87], v[124:127], v[140:143], v[72:87]
    ds_read_b64_tr_b16 v[120:121], v148 offset:36864
    ds_read_b64_tr_b16 v[122:123], v148 offset:37376
    v_mfma_f32_32x32x16_bf16 v[88:103], v[128:131], v[140:143], v[88:103]
    ds_read_b64_tr_b16 v[112:113], v148 offset:12288
    ds_read_b64_tr_b16 v[114:115], v148 offset:12800
    v_mfma_f32_32x32x16_bf16 v[8:23], v[132:135], v[124:127], v[8:23]
    v_mfma_f32_32x32x16_bf16 v[24:39], v[132:135], v[128:131], v[24:39]
    s_waitcnt lgkmcnt(0)
    s_nop 0
    v_mfma_f32_32x32x16_bf16 v[40:55], v[104:107], v[116:119], v[40:55]
    ds_read_b128 v[124:127], v147 offset:16384
    ds_read_b64_tr_b16 v[136:137], v148 offset:30720
    v_mfma_f32_32x32x16_bf16 v[56:71], v[108:111], v[116:119], v[56:71]
    ds_read_b64_tr_b16 v[138:139], v148 offset:31232
    ds_read_b128 v[128:131], v147 offset:20480
    v_mfma_f32_32x32x16_bf16 v[72:87], v[104:107], v[120:123], v[72:87]
    ds_read_b64_tr_b16 v[140:141], v148 offset:38912
    ds_read_b64_tr_b16 v[142:143], v148 offset:39424
    v_mfma_f32_32x32x16_bf16 v[88:103], v[108:111], v[120:123], v[88:103]
    ds_read_b64_tr_b16 v[132:133], v148 offset:14336
    ds_read_b64_tr_b16 v[134:135], v148 offset:14848
    v_mfma_f32_32x32x16_bf16 v[8:23], v[112:115], v[104:107], v[8:23]
    v_mfma_f32_32x32x16_bf16 v[24:39], v[112:115], v[108:111], v[24:39]
    s_waitcnt lgkmcnt(0)
    v_mfma_f32_32x32x16_bf16 v[40:55], v[124:127], v[136:139], v[40:55]
    s_barrier
    v_mfma_f32_32x32x16_bf16 v[56:71], v[128:131], v[136:139], v[56:71]
    ds_read_b128 v[156:159], v144 offset:32768
    ds_read_b64_tr_b16 v[104:105], v148 offset:40960
    ds_read_b64_tr_b16 v[106:107], v148 offset:41472
    ds_read_b128 v[160:163], v144 offset:36864
    v_mfma_f32_32x32x16_bf16 v[72:87], v[124:127], v[140:143], v[72:87]
    ds_read_b64_tr_b16 v[108:109], v148 offset:49152
    ds_read_b64_tr_b16 v[110:111], v148 offset:49664
    ds_read_b128 v[164:167], v145 offset:32768
    ds_read_b64_tr_b16 v[112:113], v148 offset:43008
    v_mfma_f32_32x32x16_bf16 v[88:103], v[128:131], v[140:143], v[88:103]
    ds_read_b64_tr_b16 v[114:115], v148 offset:43520
    ds_read_b128 v[168:171], v145 offset:36864
    ds_read_b64_tr_b16 v[116:117], v148 offset:51200
    ds_read_b64_tr_b16 v[118:119], v148 offset:51712
    v_mfma_f32_32x32x16_bf16 v[8:23], v[132:135], v[124:127], v[8:23]
    v_mfma_f32_32x32x16_bf16 v[24:39], v[132:135], v[128:131], v[24:39]
    s_waitcnt lgkmcnt(0)
    s_nop 0
    v_mfma_f32_32x32x16_bf16 v[40:55], v[156:159], v[104:107], v[40:55]
    ds_read_b128 v[172:175], v146 offset:32768
    ds_read_b64_tr_b16 v[124:125], v148 offset:45056
    v_mfma_f32_32x32x16_bf16 v[56:71], v[160:163], v[104:107], v[56:71]
    ds_read_b64_tr_b16 v[126:127], v148 offset:45568
    ds_read_b128 v[176:179], v146 offset:36864
    v_mfma_f32_32x32x16_bf16 v[72:87], v[156:159], v[108:111], v[72:87]
    ds_read_b64_tr_b16 v[128:129], v148 offset:53248
    ds_read_b64_tr_b16 v[130:131], v148 offset:53760
    v_mfma_f32_32x32x16_bf16 v[88:103], v[160:163], v[108:111], v[88:103]
    ds_read_b128 v[180:183], v147 offset:32768
    ds_read_b64_tr_b16 v[132:133], v148 offset:47104
    v_mfma_f32_32x32x16_bf16 v[40:55], v[164:167], v[112:115], v[40:55]
    ds_read_b64_tr_b16 v[134:135], v148 offset:47616
    ds_read_b128 v[184:187], v147 offset:36864
    v_mfma_f32_32x32x16_bf16 v[56:71], v[168:171], v[112:115], v[56:71]
    ds_read_b64_tr_b16 v[136:137], v148 offset:55296
    ds_read_b64_tr_b16 v[138:139], v148 offset:55808
    v_mfma_f32_32x32x16_bf16 v[72:87], v[164:167], v[116:119], v[72:87]
    v_mfma_f32_32x32x16_bf16 v[88:103], v[168:171], v[116:119], v[88:103]
    s_waitcnt lgkmcnt(0)
    v_mfma_f32_32x32x16_bf16 v[40:55], v[172:175], v[124:127], v[40:55]
    v_mfma_f32_32x32x16_bf16 v[56:71], v[176:179], v[124:127], v[56:71]
    s_barrier
    v_mfma_f32_32x32x16_bf16 v[72:87], v[172:175], v[128:131], v[72:87]
    ds_read_b128 v[188:191], v144 offset:0
    ds_read_b64_tr_b16 v[104:105], v149 offset:0
    ds_read_b64_tr_b16 v[106:107], v149 offset:512
    v_mfma_f32_32x32x16_bf16 v[88:103], v[176:179], v[128:131], v[88:103]
    ds_read_b128 v[192:195], v144 offset:4096
    ds_read_b64_tr_b16 v[108:109], v149 offset:8192
    ds_read_b64_tr_b16 v[110:111], v149 offset:8704
    v_mfma_f32_32x32x16_bf16 v[40:55], v[180:183], v[132:135], v[40:55]
    ds_read_b128 v[196:199], v145 offset:0
    ds_read_b64_tr_b16 v[112:113], v149 offset:2048
    ds_read_b64_tr_b16 v[114:115], v149 offset:2560
    v_mfma_f32_32x32x16_bf16 v[56:71], v[184:187], v[132:135], v[56:71]
    ds_read_b128 v[200:203], v145 offset:4096
    ds_read_b64_tr_b16 v[116:117], v149 offset:10240
    ds_read_b64_tr_b16 v[118:119], v149 offset:10752
    v_mfma_f32_32x32x16_bf16 v[72:87], v[180:183], v[136:139], v[72:87]
    v_mfma_f32_32x32x16_bf16 v[88:103], v[184:187], v[136:139], v[88:103]
    s_waitcnt lgkmcnt(0)
    s_nop 0
    v_mfma_f32_32x32x16_bf16 v[40:55], v[188:191], v[104:107], v[40:55]
    ds_read_b128 v[204:207], v146 offset:0
    ds_read_b64_tr_b16 v[124:125], v149 offset:4096
    v_mfma_f32_32x32x16_bf16 v[56:71], v[192:195], v[104:107], v[56:71]
    ds_read_b64_tr_b16 v[126:127], v149 offset:4608
    ds_read_b128 v[208:211], v146 offset:4096
    v_mfma_f32_32x32x16_bf16 v[72:87], v[188:191], v[108:111], v[72:87]
    ds_read_b64_tr_b16 v[128:129], v149 offset:12288
    ds_read_b64_tr_b16 v[130:131], v149 offset:12800
    v_mfma_f32_32x32x16_bf16 v[88:103], v[192:195], v[108:111], v[88:103]
    ds_read_b128 v[212:215], v147 offset:0
    ds_read_b64_tr_b16 v[132:133], v149 offset:6144
    v_mfma_f32_32x32x16_bf16 v[40:55], v[196:199], v[112:115], v[40:55]
    ds_read_b64_tr_b16 v[134:135], v149 offset:6656
    ds_read_b128 v[216:219], v147 offset:4096
    v_mfma_f32_32x32x16_bf16 v[56:71], v[200:203], v[112:115], v[56:71]
    ds_read_b64_tr_b16 v[136:137], v149 offset:14336
    ds_read_b64_tr_b16 v[138:139], v149 offset:14848
    v_mfma_f32_32x32x16_bf16 v[72:87], v[196:199], v[116:119], v[72:87]
    v_mfma_f32_32x32x16_bf16 v[88:103], v[200:203], v[116:119], v[88:103]
    s_waitcnt lgkmcnt(0)
    v_mfma_f32_32x32x16_bf16 v[40:55], v[204:207], v[124:127], v[40:55]
    v_mfma_f32_32x32x16_bf16 v[56:71], v[208:211], v[124:127], v[56:71]
    s_barrier
    v_mfma_f32_32x32x16_bf16 v[72:87], v[204:207], v[128:131], v[72:87]
    ds_read_b128 v[220:223], v144 offset:16384
    ds_read_b64_tr_b16 v[104:105], v148 offset:24576
    ds_read_b64_tr_b16 v[106:107], v148 offset:25088
    ds_read_b128 v[228:231], v145 offset:16384
    v_mfma_f32_32x32x16_bf16 v[88:103], v[208:211], v[128:131], v[88:103]
    ds_read_b64_tr_b16 v[108:109], v148 offset:26624
    ds_read_b64_tr_b16 v[110:111], v148 offset:27136
    ds_read_b128 v[236:239], v146 offset:16384
    ds_read_b64_tr_b16 v[112:113], v148 offset:28672
    v_mfma_f32_32x32x16_bf16 v[40:55], v[212:215], v[132:135], v[40:55]
    ds_read_b64_tr_b16 v[114:115], v148 offset:29184
    ds_read_b128 v[244:247], v147 offset:16384
    ds_read_b64_tr_b16 v[116:117], v148 offset:30720
    ds_read_b64_tr_b16 v[118:119], v148 offset:31232
    v_mfma_f32_32x32x16_bf16 v[56:71], v[216:219], v[132:135], v[56:71]
    ds_read_b128 v[224:227], v144 offset:20480
    ds_read_b128 v[232:235], v145 offset:20480
    ds_read_b128 v[240:243], v146 offset:20480
    ds_read_b128 v[248:251], v147 offset:20480
    v_mfma_f32_32x32x16_bf16 v[72:87], v[212:215], v[136:139], v[72:87]
    v_mfma_f32_32x32x16_bf16 v[88:103], v[216:219], v[136:139], v[88:103]
    s_waitcnt lgkmcnt(4)
    v_mfma_f32_32x32x16_bf16 v[40:55], v[220:223], v[104:107], v[40:55]
    v_mfma_f32_32x32x16_bf16 v[40:55], v[228:231], v[108:111], v[40:55]
    s_waitcnt lgkmcnt(0)
    v_mfma_f32_32x32x16_bf16 v[40:55], v[236:239], v[112:115], v[40:55]
    ds_read_b64_tr_b16 v[124:125], v148 offset:32768
    ds_read_b64_tr_b16 v[126:127], v148 offset:33280
    ds_read_b64_tr_b16 v[128:129], v148 offset:34816
    v_mfma_f32_32x32x16_bf16 v[40:55], v[244:247], v[116:119], v[40:55]
    ds_read_b64_tr_b16 v[130:131], v148 offset:35328
    ds_read_b64_tr_b16 v[132:133], v148 offset:36864
    ds_read_b64_tr_b16 v[134:135], v148 offset:37376
    v_mfma_f32_32x32x16_bf16 v[56:71], v[224:227], v[104:107], v[56:71]
    ds_read_b64_tr_b16 v[136:137], v148 offset:38912
    ds_read_b64_tr_b16 v[138:139], v148 offset:39424
    ds_read_b32 v3, v151 offset:8
    v_mfma_f32_32x32x16_bf16 v[56:71], v[232:235], v[108:111], v[56:71]
    v_mfma_f32_32x32x16_bf16 v[56:71], v[240:243], v[112:115], v[56:71]
    v_mfma_f32_32x32x16_bf16 v[56:71], v[248:251], v[116:119], v[56:71]
    s_waitcnt lgkmcnt(0)
    s_nop 0
    v_mul_f32 v252, s70, v40
    v_mul_f32 v253, s70, v41
    v_mul_f32 v254, s70, v42
    v_mul_f32 v255, s70, v43
    v_exp_f32_e64 v252, v252 clamp
    v_exp_f32_e64 v253, v253 clamp
    v_exp_f32_e64 v254, v254 clamp
    v_exp_f32_e64 v255, v255 clamp
    v_mfma_f32_32x32x16_bf16 v[72:87], v[220:223], v[124:127], v[72:87]
    v_max_f32 v40, s71, v40
    v_max_f32 v41, s71, v41
    v_max_f32 v42, s71, v42
    v_max_f32 v43, s71, v43
    v_add_f32 v40, v40, v252
    v_add_f32 v41, v41, v253
    v_add_f32_e64 v42, v42, v254
    v_mfma_f32_32x32x16_bf16 v[72:87], v[228:231], v[128:131], v[72:87]
    v_add_f32 v43, v43, v255
    v_mul_f32 v4, s70, v44
    v_mul_f32 v5, s70, v45
    s_barrier
    v_mul_f32 v6, s70, v46
    v_mul_f32 v7, s70, v47
    v_exp_f32_e64 v4, v4 clamp
    v_exp_f32_e64 v5, v5 clamp
    v_exp_f32_e64 v6, v6 clamp
    v_mfma_f32_32x32x16_bf16 v[72:87], v[236:239], v[132:135], v[72:87]
    v_exp_f32_e64 v7, v7 clamp
    v_max_f32 v44, s71, v44
    v_max_f32 v45, s71, v45
    v_max_f32 v46, s71, v46
    v_max_f32 v47, s71, v47
    v_add_f32 v44, v44, v4
    v_add_f32 v45, v45, v5
    v_mfma_f32_32x32x16_bf16 v[72:87], v[244:247], v[136:139], v[72:87]
    v_add_f32 v46, v46, v6
    v_add_f32 v47, v47, v7
    v_mul_f32 v252, s70, v48
    v_mul_f32 v253, s70, v49
    v_mul_f32 v254, s70, v50
    v_mul_f32 v255, s70, v51
    v_exp_f32_e64 v252, v252 clamp
    v_exp_f32_e64 v253, v253 clamp
    v_mfma_f32_32x32x16_bf16 v[88:103], v[224:227], v[124:127], v[88:103]
    v_exp_f32_e64 v254, v254 clamp
    v_exp_f32_e64 v255, v255 clamp
    v_max_f32 v48, s71, v48
    v_max_f32 v49, s71, v49
    v_max_f32 v50, s71, v50
    v_max_f32 v51, s71, v51
    v_add_f32_e64 v48, v48, v252
    v_mfma_f32_32x32x16_bf16 v[88:103], v[232:235], v[128:131], v[88:103]
    v_add_f32 v49, v49, v253
    v_add_f32 v50, v50, v254
    v_add_f32 v51, v51, v255
    v_mul_f32 v4, s70, v52
    v_mul_f32 v5, s70, v53
    v_mul_f32 v6, s70, v54
    v_mul_f32_e64 v7, s70, v55
    v_exp_f32_e64 v4, v4 clamp
    v_mfma_f32_32x32x16_bf16 v[88:103], v[240:243], v[132:135], v[88:103]
    v_exp_f32_e64 v5, v5 clamp
    v_exp_f32_e64 v6, v6 clamp
    v_exp_f32_e64 v7, v7 clamp
    v_max_f32 v52, s71, v52
    v_max_f32 v53, s71, v53
    v_max_f32 v54, s71, v54
    v_max_f32 v55, s71, v55
    v_mfma_f32_32x32x16_bf16 v[88:103], v[248:251], v[136:139], v[88:103]
    v_add_f32 v52, v52, v4
    v_add_f32 v53, v53, v5
    v_add_f32 v54, v54, v6
    v_add_f32 v55, v55, v7
    v_cvt_pk_bf16_f32 v104, v40, v41
    v_cvt_pk_bf16_f32 v105, v42, v43
    v_cvt_pk_bf16_f32 v106, v44, v45
    v_cvt_pk_bf16_f32 v107, v46, v47
    v_cvt_pk_bf16_f32 v108, v48, v49
    v_cvt_pk_bf16_f32 v109, v50, v51
    v_cvt_pk_bf16_f32 v110, v52, v53
    v_cvt_pk_bf16_f32 v111, v54, v55
    v_cvt_pk_bf16_f32 v72, v72, v73
    v_cvt_pk_bf16_f32 v73, v74, v75
    v_cvt_pk_bf16_f32 v74, v76, v77
    v_cvt_pk_bf16_f32 v75, v78, v79
    v_cvt_pk_bf16_f32 v76, v80, v81
    v_cvt_pk_bf16_f32 v77, v82, v83
    v_cvt_pk_bf16_f32 v78, v84, v85
    v_cvt_pk_bf16_f32 v79, v86, v87
    v_mul_f32 v252, s70, v56
    v_mul_f32 v253, s70, v57
    v_mul_f32 v254, s70, v58
    v_mul_f32 v255, s70, v59
    v_exp_f32_e64 v252, v252 clamp
    v_exp_f32_e64 v253, v253 clamp
    v_exp_f32_e64 v254, v254 clamp
    v_exp_f32_e64 v255, v255 clamp
    v_mfma_f32_32x32x16_bf16 v[124:139], v[104:107], v[72:75], 0
    v_max_f32 v56, s71, v56
    v_max_f32 v57, s71, v57
    v_max_f32 v58, s71, v58
    v_max_f32 v59, s71, v59
    v_add_f32 v56, v56, v252
    v_add_f32 v57, v57, v253
    v_mfma_f32_32x32x16_bf16 v[124:139], v[108:111], v[76:79], v[124:139]
    v_add_f32 v58, v58, v254
    v_add_f32 v59, v59, v255
    v_mul_f32 v4, s70, v60
    v_mul_f32 v5, s70, v61
    v_mul_f32 v6, s70, v62
    v_mul_f32 v7, s70, v63
    v_cvt_pk_bf16_f32 v88, v88, v89
    v_exp_f32_e64 v4, v4 clamp
    v_exp_f32_e64 v5, v5 clamp
    v_exp_f32_e64 v6, v6 clamp
    v_exp_f32_e64 v7, v7 clamp
    v_max_f32 v60, s71, v60
    v_max_f32 v61, s71, v61
    v_cvt_pk_bf16_f32 v89, v90, v91
    v_max_f32 v62, s71, v62
    v_max_f32 v63, s71, v63
    v_add_f32 v60, v60, v4
    v_add_f32 v61, v61, v5
    v_add_f32_e64 v62, v62, v6
    v_cvt_pk_bf16_f32 v90, v92, v93
    v_add_f32 v63, v63, v7
    v_mul_f32 v252, s70, v64
    v_mul_f32 v253, s70, v65
    v_mul_f32 v254, s70, v66
    v_mul_f32_e64 v255, s70, v67
    v_exp_f32_e64 v252, v252 clamp
    v_cvt_pk_bf16_f32 v91, v94, v95
    v_exp_f32_e64 v253, v253 clamp
    v_exp_f32_e64 v254, v254 clamp
    v_exp_f32_e64 v255, v255 clamp
    v_max_f32 v64, s71, v64
    v_max_f32 v65, s71, v65
    v_max_f32_e64 v66, s71, v66
    v_cvt_pk_bf16_f32 v92, v96, v97
    v_max_f32 v67, s71, v67
    v_add_f32 v64, v64, v252
    v_add_f32 v65, v65, v253
    v_add_f32 v66, v66, v254
    v_add_f32 v67, v67, v255
    v_mul_f32 v4, s70, v68
    v_cvt_pk_bf16_f32 v93, v98, v99
    v_mul_f32 v5, s70, v69
    v_mul_f32 v6, s70, v70
    v_mul_f32_e64 v7, s70, v71
    v_exp_f32_e64 v4, v4 clamp
    v_exp_f32_e64 v5, v5 clamp
    v_exp_f32_e64 v6, v6 clamp
    v_cvt_pk_bf16_f32 v94, v100, v101
    v_exp_f32_e64 v7, v7 clamp
    v_max_f32 v68, s71, v68
    v_max_f32 v69, s71, v69
    v_max_f32 v70, s71, v70
    v_max_f32 v71, s71, v71
    v_cvt_pk_bf16_f32 v95, v102, v103
    v_add_f32 v68, v68, v4
    v_add_f32 v69, v69, v5
    v_add_f32 v70, v70, v6
    v_add_f32 v71, v71, v7
    v_cvt_pk_bf16_f32 v112, v56, v57
    v_cvt_pk_bf16_f32 v113, v58, v59
    v_cvt_pk_bf16_f32 v114, v60, v61
    v_cvt_pk_bf16_f32 v115, v62, v63
    v_cvt_pk_bf16_f32 v116, v64, v65
    v_cvt_pk_bf16_f32 v117, v66, v67
    v_cvt_pk_bf16_f32 v118, v68, v69
    v_cvt_pk_bf16_f32 v119, v70, v71
    v_add_f32 v40, v40, v56
    v_add_f32 v41, v41, v57
    v_mfma_f32_32x32x16_bf16 v[124:139], v[112:115], v[88:91], v[124:139]
    v_add_f32 v42, v42, v58
    v_add_f32 v43, v43, v59
    v_add_f32 v44, v44, v60
    v_add_f32 v45, v45, v61
    v_add_f32_e64 v46, v46, v62
    v_mfma_f32_32x32x16_bf16 v[124:139], v[116:119], v[92:95], v[124:139]
    v_add_f32 v47, v47, v63
    v_add_f32 v48, v48, v64
    v_add_f32 v49, v49, v65
    v_add_f32 v50, v50, v66
    v_add_f32 v51, v51, v67
    v_add_f32 v52, v52, v68
    v_add_f32 v53, v53, v69
    v_add_f32 v54, v54, v70
    v_add_f32 v55, v55, v71
    v_add_f32 v40, v40, v48
    v_add_f32 v41, v41, v49
    v_add_f32 v42, v42, v50
    v_mov_b32 v107, v3
    v_mov_b32 v111, v3
    v_mov_b32_e64 v115, v3
    v_cndmask_b32 v104, v124, v132, s[66:67]
    v_cndmask_b32 v105, v125, v133, s[66:67]
    v_cndmask_b32 v106, v126, v134, s[66:67]
    v_cndmask_b32 v108, v127, v135, s[66:67]
    v_cndmask_b32 v109, v128, v136, s[66:67]
    v_cndmask_b32 v110, v129, v137, s[66:67]
    v_cndmask_b32 v112, v130, v138, s[66:67]
    v_cndmask_b32 v113, v131, v139, s[66:67]
    buffer_store_dwordx4 v[104:107], v152, s[56:59], s12 offen sc1
    buffer_store_dwordx4 v[108:111], v152, s[56:59], s12 offen offset:1024 sc1
    v_add_f32 v43, v43, v51
    v_add_f32 v44, v44, v52
    v_add_f32 v45, v45, v53
    v_add_f32 v46, v46, v54
    v_add_f32 v47, v47, v55
    v_add_f32 v40, v40, v44
    v_add_f32 v41, v41, v45
    v_add_f32 v42, v42, v46
    v_add_f32 v43, v43, v47
    v_add_f32 v40, v40, v42
    v_add_f32 v41, v41, v43
    v_add_f32 v40, v40, v41
    v_mov_b32 v41, v40
    s_nop 1
    v_permlane32_swap_b32 v40, v41
    v_add_f32 v114, v40, v41
    buffer_store_dwordx4 v[112:115], v152, s[56:59], s12 offen offset:2048 sc1
    ds_read_b64_tr_b16 v[56:57], v148 offset:16384
    ds_read_b64_tr_b16 v[58:59], v148 offset:16896
    ds_read_b64_tr_b16 v[60:61], v148 offset:18432
    ds_read_b64_tr_b16 v[62:63], v148 offset:18944
    ds_read_b64_tr_b16 v[64:65], v148 offset:20480
    ds_read_b64_tr_b16 v[66:67], v148 offset:20992
    ds_read_b64_tr_b16 v[68:69], v148 offset:22528
    ds_read_b64_tr_b16 v[70:71], v148 offset:23040
    s_waitcnt lgkmcnt(6)
    v_mfma_f32_32x32x16_bf16 v[8:23], v[56:59], v[156:159], v[8:23]
    ds_read_b64_tr_b16 v[72:73], v148 offset:0
    ds_read_b64_tr_b16 v[74:75], v148 offset:512
    s_waitcnt lgkmcnt(6)
    v_mfma_f32_32x32x16_bf16 v[8:23], v[60:63], v[164:167], v[8:23]
    ds_read_b64_tr_b16 v[76:77], v148 offset:2048
    ds_read_b64_tr_b16 v[78:79], v148 offset:2560
    s_waitcnt lgkmcnt(6)
    v_mfma_f32_32x32x16_bf16 v[8:23], v[64:67], v[172:175], v[8:23]
    ds_read_b64_tr_b16 v[80:81], v148 offset:4096
    ds_read_b64_tr_b16 v[82:83], v148 offset:4608
    s_waitcnt lgkmcnt(6)
    v_mfma_f32_32x32x16_bf16 v[8:23], v[68:71], v[180:183], v[8:23]
    ds_read_b64_tr_b16 v[84:85], v148 offset:6144
    ds_read_b64_tr_b16 v[86:87], v148 offset:6656
    s_waitcnt lgkmcnt(6)
    v_mfma_f32_32x32x16_bf16 v[8:23], v[72:75], v[188:191], v[8:23]
    ds_read_b64_tr_b16 v[88:89], v148 offset:8192
    ds_read_b64_tr_b16 v[90:91], v148 offset:8704
    s_waitcnt lgkmcnt(6)
    v_mfma_f32_32x32x16_bf16 v[8:23], v[76:79], v[196:199], v[8:23]
    ds_read_b64_tr_b16 v[92:93], v148 offset:10240
    ds_read_b64_tr_b16 v[94:95], v148 offset:10752
    s_waitcnt lgkmcnt(6)
    v_mfma_f32_32x32x16_bf16 v[8:23], v[80:83], v[204:207], v[8:23]
    ds_read_b64_tr_b16 v[96:97], v148 offset:12288
    ds_read_b64_tr_b16 v[98:99], v148 offset:12800
    s_waitcnt lgkmcnt(6)
    v_mfma_f32_32x32x16_bf16 v[8:23], v[84:87], v[212:215], v[8:23]
    ds_read_b64_tr_b16 v[100:101], v148 offset:14336
    ds_read_b64_tr_b16 v[102:103], v148 offset:14848
    s_waitcnt lgkmcnt(6)
    v_mfma_f32_32x32x16_bf16 v[8:23], v[88:91], v[220:223], v[8:23]
    s_waitcnt lgkmcnt(4)
    v_mfma_f32_32x32x16_bf16 v[8:23], v[92:95], v[228:231], v[8:23]
    s_waitcnt lgkmcnt(2)
    v_mfma_f32_32x32x16_bf16 v[8:23], v[96:99], v[236:239], v[8:23]
    s_waitcnt lgkmcnt(0)
    v_mfma_f32_32x32x16_bf16 v[8:23], v[100:103], v[244:247], v[8:23]
    v_mfma_f32_32x32x16_bf16 v[24:39], v[56:59], v[160:163], v[24:39]
    v_mfma_f32_32x32x16_bf16 v[24:39], v[60:63], v[168:171], v[24:39]
    s_nop 9
    v_mul_f32 v252, s70, v8
    v_mul_f32 v253, s70, v9
    v_mul_f32 v254, s70, v10
    v_mul_f32_e64 v255, s70, v11
    v_exp_f32_e64 v252, v252 clamp
    v_exp_f32_e64 v253, v253 clamp
    v_mfma_f32_32x32x16_bf16 v[24:39], v[64:67], v[176:179], v[24:39]
    v_exp_f32_e64 v254, v254 clamp
    v_exp_f32_e64 v255, v255 clamp
    v_max_f32 v8, s71, v8
    v_max_f32 v9, s71, v9
    v_max_f32_e64 v10, s71, v10
    v_mfma_f32_32x32x16_bf16 v[24:39], v[68:71], v[184:187], v[24:39]
    v_max_f32 v11, s71, v11
    v_add_f32 v8, v8, v252
    v_add_f32 v9, v9, v253
    v_add_f32 v10, v10, v254
    v_add_f32_e64 v11, v11, v255
    v_mfma_f32_32x32x16_bf16 v[24:39], v[72:75], v[192:195], v[24:39]
    v_mul_f32 v4, s70, v12
    v_mul_f32 v5, s70, v13
    v_mul_f32 v6, s70, v14
    v_mul_f32 v7, s70, v15
    v_exp_f32_e64 v4, v4 clamp
    v_mfma_f32_32x32x16_bf16 v[24:39], v[76:79], v[200:203], v[24:39]
    v_exp_f32_e64 v5, v5 clamp
    v_exp_f32_e64 v6, v6 clamp
    v_exp_f32_e64 v7, v7 clamp
    v_max_f32 v12, s71, v12
    v_max_f32 v13, s71, v13
    v_mfma_f32_32x32x16_bf16 v[24:39], v[80:83], v[208:211], v[24:39]
    v_max_f32 v14, s71, v14
    v_max_f32 v15, s71, v15
    v_add_f32 v12, v12, v4
    v_add_f32 v13, v13, v5
    v_add_f32 v14, v14, v6
    v_add_f32 v15, v15, v7
    v_mfma_f32_32x32x16_bf16 v[24:39], v[84:87], v[216:219], v[24:39]
    v_cvt_pk_bf16_f32 v8, v8, v9
    v_cvt_pk_bf16_f32 v9, v10, v11
    v_cvt_pk_bf16_f32 v10, v12, v13
    v_cvt_pk_bf16_f32 v11, v14, v15
    buffer_store_dwordx4 v[8:11], v152, s[56:59], s13 offen sc1
    v_mfma_f32_32x32x16_bf16 v[24:39], v[88:91], v[224:227], v[24:39]
    v_mul_f32 v252, s70, v16
    v_mul_f32 v253, s70, v17
    v_mul_f32 v254, s70, v18
    v_mul_f32 v255, s70, v19
    v_exp_f32_e64 v252, v252 clamp
    v_mfma_f32_32x32x16_bf16 v[24:39], v[92:95], v[232:235], v[24:39]
    v_exp_f32_e64 v253, v253 clamp
    v_exp_f32_e64 v254, v254 clamp
    v_exp_f32_e64 v255, v255 clamp
    v_max_f32 v16, s71, v16
    v_max_f32 v17, s71, v17
    v_mfma_f32_32x32x16_bf16 v[24:39], v[96:99], v[240:243], v[24:39]
    v_max_f32 v18, s71, v18
    v_max_f32 v19, s71, v19
    v_add_f32 v16, v16, v252
    v_add_f32 v17, v17, v253
    v_add_f32_e64 v18, v18, v254
    v_mfma_f32_32x32x16_bf16 v[24:39], v[100:103], v[248:251], v[24:39]
    v_add_f32 v19, v19, v255
    v_mul_f32 v4, s70, v20
    v_mul_f32 v5, s70, v21
    v_mul_f32 v6, s70, v22
    v_mul_f32_e64 v7, s70, v23
    v_exp_f32_e64 v4, v4 clamp
    v_exp_f32_e64 v5, v5 clamp
    v_exp_f32_e64 v6, v6 clamp
    v_exp_f32_e64 v7, v7 clamp
    v_max_f32 v20, s71, v20
    v_max_f32 v21, s71, v21
    v_max_f32 v22, s71, v22
    v_max_f32 v23, s71, v23
    v_add_f32 v20, v20, v4
    v_add_f32 v21, v21, v5
    v_add_f32 v22, v22, v6
    v_add_f32 v23, v23, v7
    v_cvt_pk_bf16_f32 v16, v16, v17
    v_cvt_pk_bf16_f32 v17, v18, v19
    v_cvt_pk_bf16_f32 v18, v20, v21
    v_cvt_pk_bf16_f32 v19, v22, v23
    buffer_store_dwordx4 v[16:19], v152, s[56:59], s13 offen offset:1024 sc1
    v_mul_f32 v252, s70, v24
    v_mul_f32 v253, s70, v25
    v_mul_f32 v254, s70, v26
    v_mul_f32 v255, s70, v27
    v_exp_f32_e64 v252, v252 clamp
    v_exp_f32_e64 v253, v253 clamp
    v_exp_f32_e64 v254, v254 clamp
    v_exp_f32_e64 v255, v255 clamp
    v_max_f32 v24, s71, v24
    v_max_f32 v25, s71, v25
    v_max_f32 v26, s71, v26
    v_max_f32 v27, s71, v27
    v_add_f32 v24, v24, v252
    v_add_f32 v25, v25, v253
    v_add_f32 v26, v26, v254
    v_add_f32 v27, v27, v255
    v_mul_f32 v4, s70, v28
    v_mul_f32 v5, s70, v29
    v_mul_f32 v6, s70, v30
    v_mul_f32 v7, s70, v31
    v_exp_f32_e64 v4, v4 clamp
    v_exp_f32_e64 v5, v5 clamp
    v_exp_f32_e64 v6, v6 clamp
    v_exp_f32_e64 v7, v7 clamp
    v_max_f32 v28, s71, v28
    v_max_f32 v29, s71, v29
    v_max_f32 v30, s71, v30
    v_max_f32 v31, s71, v31
    v_add_f32 v28, v28, v4
    v_add_f32 v29, v29, v5
    v_add_f32 v30, v30, v6
    v_add_f32 v31, v31, v7
    v_cvt_pk_bf16_f32 v24, v24, v25
    v_cvt_pk_bf16_f32 v25, v26, v27
    v_cvt_pk_bf16_f32 v26, v28, v29
    v_cvt_pk_bf16_f32 v27, v30, v31
    buffer_store_dwordx4 v[24:27], v152, s[56:59], s15 offen sc1
    v_mul_f32 v252, s70, v32
    v_mul_f32 v253, s70, v33
    v_mul_f32 v254, s70, v34
    v_mul_f32 v255, s70, v35
    v_exp_f32_e64 v252, v252 clamp
    v_exp_f32_e64 v253, v253 clamp
    v_exp_f32_e64 v254, v254 clamp
    v_exp_f32_e64 v255, v255 clamp
    v_max_f32 v32, s71, v32
    v_max_f32 v33, s71, v33
    v_max_f32 v34, s71, v34
    v_max_f32 v35, s71, v35
    v_add_f32 v32, v32, v252
    v_add_f32 v33, v33, v253
    v_add_f32 v34, v34, v254
    v_add_f32 v35, v35, v255
    v_mul_f32 v4, s70, v36
    v_mul_f32 v5, s70, v37
    v_mul_f32 v6, s70, v38
    v_mul_f32 v7, s70, v39
    v_exp_f32_e64 v4, v4 clamp
    v_exp_f32_e64 v5, v5 clamp
    v_exp_f32_e64 v6, v6 clamp
    v_exp_f32_e64 v7, v7 clamp
    v_max_f32 v36, s71, v36
    v_max_f32 v37, s71, v37
    v_max_f32 v38, s71, v38
    v_max_f32 v39, s71, v39
    v_add_f32 v36, v36, v4
    v_add_f32 v37, v37, v5
    v_add_f32 v38, v38, v6
    v_add_f32 v39, v39, v7
    v_cvt_pk_bf16_f32 v32, v32, v33
    v_cvt_pk_bf16_f32 v33, v34, v35
    v_cvt_pk_bf16_f32 v34, v36, v37
    v_cvt_pk_bf16_f32 v35, v38, v39
    buffer_store_dwordx4 v[32:35], v152, s[56:59], s15 offen offset:1024 sc1
    ds_write_b32 v151, v151 offset:16
    s_mov_b32 s24, 0
    s_branch L_p2comp
.p2align 3
L_conv:
    s_lshl_b32 s7, s4, 4
    s_add_u32 s7, s7, s5
    s_and_b32 s10, s3, 3
    s_lshl_b32 s8, s7, 2
    s_add_u32 s8, s8, s10
    s_lshl_b32 s9, s8, 8
    v_lshl_add_u32 v1, v0, 2, s9
    s_lshl_b32 s9, s8, 1
    v_mov_b32 v2, s9
    s_mul_i32 s73, s10, 31232
    v_lshl_add_u32 v31, v0, 3, s73
    s_mov_b32 s70, 1069066811
    s_cmp_ge_u32 s3, 4
    s_waitcnt lgkmcnt(0)
    global_load_ushort v10, v2, s[36:37]
    global_load_dword v4, v1, s[24:25] nt
    global_load_dword v5, v1, s[26:27] nt
    s_cbranch_scc1 L_cload
    s_nop 0
    global_load_dword v6, v1, s[28:29] nt
    global_load_dword v7, v1, s[30:31] nt
    global_load_dword v8, v1, s[32:33] nt
    global_load_dword v9, v1, s[34:35] nt
    global_load_ushort v11, v2, s[38:39]
    s_mov_b32 s71, 1094232635
    s_mov_b32 s72, 1067645315
    s_mov_b32 s56, s46
    s_mov_b32 s57, s47
    s_mov_b32 s58, 6291456
    s_mov_b32 s59, 0x20000
    s_mov_b32 s60, s44
    s_mov_b32 s61, s45
    s_mov_b32 s62, 256
    s_mov_b32 s63, 0x20000
    s_cmp_lg_u32 s8, 0
    s_cbranch_scc1 L_c_nonon
    s_memrealtime s[64:65]
    s_waitcnt lgkmcnt(0)
    s_or_b32 s65, s65, 0x80000000
    v_mov_b32 v100, s64
    v_mov_b32 v101, s65
    s_mov_b64 exec, 1
    buffer_store_dwordx2 v[100:101], off, s[60:63], 0 sc1
    s_mov_b64 exec, -1
L_c_nonon:
    v_and_b32 v12, 31, v0
    v_lshrrev_b32_e64 v13, 5, v0
    v_lshlrev_b32 v14, v12, 2
    v_add_u32_e64 v14, -1, v14
    v_and_b32 v14, 8951808, v14
    v_bcnt_u32_b32 v14, v14, 0
    v_sub_u32_e64 v14, v12, v14
    v_mul_u32_u24 v14, 528, v14
    v_lshl_add_u32 v15, v13, 4, s73
    v_add_u32_e64 v30, v14, v15
    v_mul_u32_u24 v14, 528, v12
    v_add_u32 v14, 14256, v14
    v_add_u32_e64 v29, v14, v15
    v_lshl_add_u32 v14, v12, 4, s73
    v_lshl_add_u32 v28, v13, 3, v14
    v_lshl_add_u32 v27, v13, 9, v14
    v_lshl_add_u32 v26, v13, 10, v14
    v_and_b32 v14, 15, v0
    v_sub_u32 v15, 15, v13
    v_min_u32_e64 v14, v14, v15
    v_mul_u32_u24 v15, 4224, v13
    v_lshl_add_u32 v14, v14, 2, s73
    v_add_u32 v25, v14, v15
    v_and_b32 v14, 15, v0
    v_lshrrev_b32 v15, 4, v0
    v_lshlrev_b32 v16, 2, v14
    v_lshl_add_u32 v16, v15, 4, v16
    v_and_b32_e64 v17, 1, v0
    v_mul_u32_u24 v18, 4220, v17
    v_sub_u32_e64 v16, v16, v18
    v_add_u32 v16, 4224, v16
    v_add_u32_e64 v24, s73, v16
    s_mul_i32 s11, s3, 9152
    s_add_u32 s11, s11, 125376
    v_mul_u32_u24 v18, 4576, v17
    v_lshl_add_u32 v18, v15, 4, v18
    v_lshrrev_b32 v16, 1, v14
    v_lshlrev_b32 v19, 6, v16
    v_sub_u32 v18, v18, v19
    v_add_u32 v23, s11, v18
    v_lshl_add_u32 v18, v15, 1, v17
    v_lshlrev_b32_e64 v18, 4, v18
    v_lshl_add_u32 v22, v16, 7, v18
    v_cmp_eq_u32 s[12:13], 1, v17
    v_cmp_eq_u32 s[14:15], 0, v0
    s_lshl_b32 s9, s8, 12
    s_nop 0
    s_add_u32 s9, s9, 2097152
    s_mov_b32 s0, 8448
    s_mov_b32 s1, 31232
    s_mov_b32 s23, 124928
    s_mov_b32 s22, 24832
    s_mov_b32 s73, 31232
    s_mov_b32 s75, 161536
    s_lshl_b32 s64, s7, 7
    s_add_u32 s74, s64, 4308992
    buffer_load_dword v254, off, s[56:59], s74
    s_waitcnt vmcnt(2)
    v_lshlrev_b32_e64 v36, 16, v6
    v_and_b32 v37, 0xffff0000, v6
    v_lshlrev_b32_e64 v38, 16, v7
    v_and_b32 v39, 0xffff0000, v7
    v_lshlrev_b32_e64 v40, 16, v8
    v_and_b32 v41, 0xffff0000, v8
    v_lshlrev_b32_e64 v42, 16, v9
    v_and_b32 v43, 0xffff0000, v9
    v_pk_mul_f32 v[44:45], v[36:37], v[40:41]
    v_pk_mul_f32 v[46:47], v[38:39], v[40:41]
    v_pk_fma_f32 v[44:45], v[38:39], v[42:43], v[44:45] neg_lo:[1,0,0] neg_hi:[1,0,0]
    v_pk_fma_f32 v[46:47], v[36:37], v[42:43], v[46:47]
    v_max3_f32 v13, |v44|, |v45|, |v46|
    v_max_f32 v13, |v47|, v13
    v_lshlrev_b32 v10, 16, v10
    v_mul_f32 v10, s70, v10
    v_exp_f32 v10, v10
    v_lshlrev_b32 v32, 16, v4
    v_max_f32_dpp v13, v13, v13 row_shr:1 row_mask:0xf bank_mask:0xf
    v_and_b32 v33, 0xffff0000, v4
    v_lshlrev_b32_e64 v34, 16, v5
    v_and_b32 v35, 0xffff0000, v5
    v_max_f32_dpp v13, v13, v13 row_shr:2 row_mask:0xf bank_mask:0xf
    v_cvt_pk_bf16_f32 v10, v10, v10
    v_and_b32 v12, 0xffff0000, v10
    v_max_f32_dpp v13, v13, v13 row_shr:4 row_mask:0xf bank_mask:0xf
    v_mul_f32 v32, v12, v32
    v_mul_f32 v33, v12, v33
    v_mul_f32_e64 v34, v12, v34
    v_max_f32_dpp v13, v13, v13 row_shr:8 row_mask:0xf bank_mask:0xf
    v_mul_f32 v35, v12, v35
    v_mul_f32 v32, s71, v32
    v_mul_f32_e64 v33, s71, v33
    v_max_f32_dpp v13, v13, v13 row_bcast:15 row_mask:0xa bank_mask:0xf
    v_mul_f32 v34, s72, v34
    v_mul_f32 v35, s72, v35
    v_max_f32_dpp v13, v13, v13 row_bcast:31 row_mask:0xc bank_mask:0xf
    v_rndne_f32 v84, v34
    v_rndne_f32 v85, v35
    v_readlane_b32 s66, v13, 63
    v_exp_f32 v86, v32
    v_exp_f32 v87, v33
    v_sub_f32 v84, v34, v84
    s_lshr_b32 s66, s66, 23
    v_sub_f32 v85, v35, v85
    s_max_u32 s66, s66, 1
    v_cos_f32_e64 v60, v84
    s_min_u32 s66, s66, 253
    v_cos_f32 v61, v85
    s_lshl_b32 s67, s66, 23
    v_sin_f32_e64 v62, v84
    s_sub_u32 s66, 254, s66
    v_sin_f32 v63, v85
    s_lshl_b32 s66, s66, 23
    v_pk_mul_f32 v[60:61], v[60:61], v[86:87]
    v_pk_mul_f32 v[62:63], v[62:63], v[86:87]
    v_mul_f32 v68, s66, v44
    v_mul_f32 v69, s66, v45
    v_mul_f32 v70, s66, -v46
    v_mul_f32 v71, s66, -v47
    v_cvt_pk_f16_f32 v96, v68, v69
    v_cvt_pk_f16_f32 v97, v70, v71
    ds_write_b64 v31, v[96:97] offset:14256
    v_pk_mul_f32 v[72:73], v[68:69], v[60:61]
    v_pk_mul_f32 v[74:75], v[70:71], v[60:61]
    v_pk_fma_f32 v[72:73], v[70:71], v[62:63], v[72:73]
    v_pk_fma_f32 v[74:75], v[68:69], v[62:63], v[74:75] neg_lo:[1,0,0] neg_hi:[1,0,0]
    v_cvt_pk_f16_f32 v98, v72, v73
    v_cvt_pk_f16_f32 v99, v74, v75
    ds_write_b64 v31, v[98:99] offset:14784
    v_pk_mul_f32 v[68:69], v[72:73], v[60:61]
    v_pk_mul_f32 v[70:71], v[74:75], v[60:61]
    v_pk_fma_f32 v[68:69], v[74:75], v[62:63], v[68:69]
    v_pk_fma_f32 v[70:71], v[72:73], v[62:63], v[70:71] neg_lo:[1,0,0] neg_hi:[1,0,0]
    v_cvt_pk_f16_f32 v96, v68, v69
    v_cvt_pk_f16_f32 v97, v70, v71
    ds_write_b64 v31, v[96:97] offset:15312
    v_pk_mul_f32 v[72:73], v[68:69], v[60:61]
    v_pk_mul_f32 v[74:75], v[70:71], v[60:61]
    v_pk_fma_f32 v[72:73], v[70:71], v[62:63], v[72:73]
    v_pk_fma_f32 v[74:75], v[68:69], v[62:63], v[74:75] neg_lo:[1,0,0] neg_hi:[1,0,0]
    v_cvt_pk_f16_f32 v98, v72, v73
    v_cvt_pk_f16_f32 v99, v74, v75
    ds_write_b64 v31, v[98:99] offset:15840
    v_pk_mul_f32 v[68:69], v[72:73], v[60:61]
    v_pk_mul_f32 v[70:71], v[74:75], v[60:61]
    v_pk_fma_f32 v[68:69], v[74:75], v[62:63], v[68:69]
    v_pk_fma_f32 v[70:71], v[72:73], v[62:63], v[70:71] neg_lo:[1,0,0] neg_hi:[1,0,0]
    v_cvt_pk_f16_f32 v96, v68, v69
    v_cvt_pk_f16_f32 v97, v70, v71
    ds_write_b64 v31, v[96:97] offset:16368
    v_pk_mul_f32 v[72:73], v[68:69], v[60:61]
    v_pk_mul_f32 v[74:75], v[70:71], v[60:61]
    v_pk_fma_f32 v[72:73], v[70:71], v[62:63], v[72:73]
    v_pk_fma_f32 v[74:75], v[68:69], v[62:63], v[74:75] neg_lo:[1,0,0] neg_hi:[1,0,0]
    v_cvt_pk_f16_f32 v98, v72, v73
    v_cvt_pk_f16_f32 v99, v74, v75
    ds_write_b64 v31, v[98:99] offset:16896
    v_pk_mul_f32 v[68:69], v[72:73], v[60:61]
    v_pk_mul_f32 v[70:71], v[74:75], v[60:61]
    v_pk_fma_f32 v[68:69], v[74:75], v[62:63], v[68:69]
    v_pk_fma_f32 v[70:71], v[72:73], v[62:63], v[70:71] neg_lo:[1,0,0] neg_hi:[1,0,0]
    v_cvt_pk_f16_f32 v96, v68, v69
    v_cvt_pk_f16_f32 v97, v70, v71
    ds_write_b64 v31, v[96:97] offset:17424
    v_pk_mul_f32 v[72:73], v[68:69], v[60:61]
    v_pk_mul_f32 v[74:75], v[70:71], v[60:61]
    v_pk_fma_f32 v[72:73], v[70:71], v[62:63], v[72:73]
    v_pk_fma_f32 v[74:75], v[68:69], v[62:63], v[74:75] neg_lo:[1,0,0] neg_hi:[1,0,0]
    v_cvt_pk_f16_f32 v98, v72, v73
    v_cvt_pk_f16_f32 v99, v74, v75
    ds_write_b64 v31, v[98:99] offset:17952
    v_pk_mul_f32 v[68:69], v[72:73], v[60:61]
    v_pk_mul_f32 v[70:71], v[74:75], v[60:61]
    v_pk_fma_f32 v[68:69], v[74:75], v[62:63], v[68:69]
    v_pk_fma_f32 v[70:71], v[72:73], v[62:63], v[70:71] neg_lo:[1,0,0] neg_hi:[1,0,0]
    v_cvt_pk_f16_f32 v96, v68, v69
    v_cvt_pk_f16_f32 v97, v70, v71
    ds_write_b64 v31, v[96:97] offset:18480
    v_pk_mul_f32 v[72:73], v[68:69], v[60:61]
    v_pk_mul_f32 v[74:75], v[70:71], v[60:61]
    v_pk_fma_f32 v[72:73], v[70:71], v[62:63], v[72:73]
    v_pk_fma_f32 v[74:75], v[68:69], v[62:63], v[74:75] neg_lo:[1,0,0] neg_hi:[1,0,0]
    v_cvt_pk_f16_f32 v98, v72, v73
    v_cvt_pk_f16_f32 v99, v74, v75
    ds_write_b64 v31, v[98:99] offset:19008
    v_pk_mul_f32 v[68:69], v[72:73], v[60:61]
    v_pk_mul_f32 v[70:71], v[74:75], v[60:61]
    v_pk_fma_f32 v[68:69], v[74:75], v[62:63], v[68:69]
    v_pk_fma_f32 v[70:71], v[72:73], v[62:63], v[70:71] neg_lo:[1,0,0] neg_hi:[1,0,0]
    v_cvt_pk_f16_f32 v96, v68, v69
    v_cvt_pk_f16_f32 v97, v70, v71
    ds_write_b64 v31, v[96:97] offset:19536
    v_pk_mul_f32 v[72:73], v[68:69], v[60:61]
    v_pk_mul_f32 v[74:75], v[70:71], v[60:61]
    v_pk_fma_f32 v[72:73], v[70:71], v[62:63], v[72:73]
    v_pk_fma_f32 v[74:75], v[68:69], v[62:63], v[74:75] neg_lo:[1,0,0] neg_hi:[1,0,0]
    v_cvt_pk_f16_f32 v98, v72, v73
    v_cvt_pk_f16_f32 v99, v74, v75
    ds_write_b64 v31, v[98:99] offset:20064
    v_pk_mul_f32 v[68:69], v[72:73], v[60:61]
    v_pk_mul_f32 v[70:71], v[74:75], v[60:61]
    v_pk_fma_f32 v[68:69], v[74:75], v[62:63], v[68:69]
    v_pk_fma_f32 v[70:71], v[72:73], v[62:63], v[70:71] neg_lo:[1,0,0] neg_hi:[1,0,0]
    v_cvt_pk_f16_f32 v96, v68, v69
    v_cvt_pk_f16_f32 v97, v70, v71
    ds_write_b64 v31, v[96:97] offset:20592
    v_pk_mul_f32 v[72:73], v[68:69], v[60:61]
    v_pk_mul_f32 v[74:75], v[70:71], v[60:61]
    v_pk_fma_f32 v[72:73], v[70:71], v[62:63], v[72:73]
    v_pk_fma_f32 v[74:75], v[68:69], v[62:63], v[74:75] neg_lo:[1,0,0] neg_hi:[1,0,0]
    v_cvt_pk_f16_f32 v98, v72, v73
    v_cvt_pk_f16_f32 v99, v74, v75
    ds_write_b64 v31, v[98:99] offset:21120
    v_pk_mul_f32 v[68:69], v[72:73], v[60:61]
    v_pk_mul_f32 v[70:71], v[74:75], v[60:61]
    v_pk_fma_f32 v[68:69], v[74:75], v[62:63], v[68:69]
    v_pk_fma_f32 v[70:71], v[72:73], v[62:63], v[70:71] neg_lo:[1,0,0] neg_hi:[1,0,0]
    v_cvt_pk_f16_f32 v96, v68, v69
    v_cvt_pk_f16_f32 v97, v70, v71
    ds_write_b64 v31, v[96:97] offset:21648
    v_pk_mul_f32 v[72:73], v[68:69], v[60:61]
    v_pk_mul_f32 v[74:75], v[70:71], v[60:61]
    v_pk_fma_f32 v[72:73], v[70:71], v[62:63], v[72:73]
    v_pk_fma_f32 v[74:75], v[68:69], v[62:63], v[74:75] neg_lo:[1,0,0] neg_hi:[1,0,0]
    v_cvt_pk_f16_f32 v98, v72, v73
    v_cvt_pk_f16_f32 v99, v74, v75
    ds_write_b64 v31, v[98:99] offset:22176
    v_pk_mul_f32 v[68:69], v[72:73], v[60:61]
    v_pk_mul_f32 v[70:71], v[74:75], v[60:61]
    v_pk_fma_f32 v[68:69], v[74:75], v[62:63], v[68:69]
    v_pk_fma_f32 v[70:71], v[72:73], v[62:63], v[70:71] neg_lo:[1,0,0] neg_hi:[1,0,0]
    v_cvt_pk_f16_f32 v96, v68, v69
    v_cvt_pk_f16_f32 v97, v70, v71
    ds_write_b64 v31, v[96:97] offset:22704
    v_pk_mul_f32 v[72:73], v[68:69], v[60:61]
    v_pk_mul_f32 v[74:75], v[70:71], v[60:61]
    v_pk_fma_f32 v[72:73], v[70:71], v[62:63], v[72:73]
    v_pk_fma_f32 v[74:75], v[68:69], v[62:63], v[74:75] neg_lo:[1,0,0] neg_hi:[1,0,0]
    v_cvt_pk_f16_f32 v98, v72, v73
    v_cvt_pk_f16_f32 v99, v74, v75
    ds_write_b64 v31, v[98:99] offset:23232
    v_pk_mul_f32 v[68:69], v[72:73], v[60:61]
    v_pk_mul_f32 v[70:71], v[74:75], v[60:61]
    v_pk_fma_f32 v[68:69], v[74:75], v[62:63], v[68:69]
    v_pk_fma_f32 v[70:71], v[72:73], v[62:63], v[70:71] neg_lo:[1,0,0] neg_hi:[1,0,0]
    v_cvt_pk_f16_f32 v96, v68, v69
    v_cvt_pk_f16_f32 v97, v70, v71
    ds_write_b64 v31, v[96:97] offset:23760
    v_pk_mul_f32 v[72:73], v[68:69], v[60:61]
    v_pk_mul_f32 v[74:75], v[70:71], v[60:61]
    v_pk_fma_f32 v[72:73], v[70:71], v[62:63], v[72:73]
    v_pk_fma_f32 v[74:75], v[68:69], v[62:63], v[74:75] neg_lo:[1,0,0] neg_hi:[1,0,0]
    v_cvt_pk_f16_f32 v98, v72, v73
    v_cvt_pk_f16_f32 v99, v74, v75
    ds_write_b64 v31, v[98:99] offset:24288
    v_pk_mul_f32 v[68:69], v[72:73], v[60:61]
    v_pk_mul_f32 v[70:71], v[74:75], v[60:61]
    v_pk_fma_f32 v[68:69], v[74:75], v[62:63], v[68:69]
    v_pk_fma_f32 v[70:71], v[72:73], v[62:63], v[70:71] neg_lo:[1,0,0] neg_hi:[1,0,0]
    v_cvt_pk_f16_f32 v96, v68, v69
    v_cvt_pk_f16_f32 v97, v70, v71
    ds_write_b64 v31, v[96:97] offset:24816
    s_waitcnt vmcnt(0)
    s_nop 0
    v_pk_mul_f32 v[72:73], v[68:69], v[60:61]
    v_pk_mul_f32 v[74:75], v[70:71], v[60:61]
    v_pk_fma_f32 v[72:73], v[70:71], v[62:63], v[72:73]
    v_pk_fma_f32 v[74:75], v[68:69], v[62:63], v[74:75] neg_lo:[1,0,0] neg_hi:[1,0,0]
    v_cvt_pk_f16_f32 v98, v72, v73
    v_cvt_pk_f16_f32 v99, v74, v75
    ds_write_b64 v31, v[98:99] offset:25344
    v_pk_mul_f32 v[68:69], v[72:73], v[60:61]
    v_pk_mul_f32 v[70:71], v[74:75], v[60:61]
    v_pk_fma_f32 v[68:69], v[74:75], v[62:63], v[68:69]
    v_pk_fma_f32 v[70:71], v[72:73], v[62:63], v[70:71] neg_lo:[1,0,0] neg_hi:[1,0,0]
    v_cvt_pk_f16_f32 v96, v68, v69
    v_cvt_pk_f16_f32 v97, v70, v71
    ds_write_b64 v31, v[96:97] offset:25872
    v_pk_mul_f32 v[72:73], v[68:69], v[60:61]
    v_pk_mul_f32 v[74:75], v[70:71], v[60:61]
    v_pk_fma_f32 v[72:73], v[70:71], v[62:63], v[72:73]
    v_pk_fma_f32 v[74:75], v[68:69], v[62:63], v[74:75] neg_lo:[1,0,0] neg_hi:[1,0,0]
    v_cvt_pk_f16_f32 v98, v72, v73
    v_cvt_pk_f16_f32 v99, v74, v75
    ds_write_b64 v31, v[98:99] offset:26400
    v_pk_mul_f32 v[68:69], v[72:73], v[60:61]
    v_pk_mul_f32 v[70:71], v[74:75], v[60:61]
    v_pk_fma_f32 v[68:69], v[74:75], v[62:63], v[68:69]
    v_pk_fma_f32 v[70:71], v[72:73], v[62:63], v[70:71] neg_lo:[1,0,0] neg_hi:[1,0,0]
    v_cvt_pk_f16_f32 v96, v68, v69
    v_cvt_pk_f16_f32 v97, v70, v71
    ds_write_b64 v31, v[96:97] offset:26928
    v_pk_mul_f32 v[72:73], v[68:69], v[60:61]
    v_pk_mul_f32 v[74:75], v[70:71], v[60:61]
    v_pk_fma_f32 v[72:73], v[70:71], v[62:63], v[72:73]
    v_pk_fma_f32 v[74:75], v[68:69], v[62:63], v[74:75] neg_lo:[1,0,0] neg_hi:[1,0,0]
    v_cvt_pk_f16_f32 v98, v72, v73
    v_cvt_pk_f16_f32 v99, v74, v75
    ds_write_b64 v31, v[98:99] offset:27456
    v_pk_mul_f32 v[68:69], v[72:73], v[60:61]
    v_pk_mul_f32 v[70:71], v[74:75], v[60:61]
    v_pk_fma_f32 v[68:69], v[74:75], v[62:63], v[68:69]
    v_pk_fma_f32 v[70:71], v[72:73], v[62:63], v[70:71] neg_lo:[1,0,0] neg_hi:[1,0,0]
    v_cvt_pk_f16_f32 v96, v68, v69
    v_cvt_pk_f16_f32 v97, v70, v71
    ds_write_b64 v31, v[96:97] offset:27984
    v_pk_mul_f32 v[72:73], v[68:69], v[60:61]
    v_pk_mul_f32 v[74:75], v[70:71], v[60:61]
    v_pk_fma_f32 v[72:73], v[70:71], v[62:63], v[72:73]
    v_pk_fma_f32 v[74:75], v[68:69], v[62:63], v[74:75] neg_lo:[1,0,0] neg_hi:[1,0,0]
    v_cvt_pk_f16_f32 v98, v72, v73
    v_cvt_pk_f16_f32 v99, v74, v75
    ds_write_b64 v31, v[98:99] offset:28512
    v_pk_mul_f32 v[68:69], v[72:73], v[60:61]
    v_pk_mul_f32 v[70:71], v[74:75], v[60:61]
    v_pk_fma_f32 v[68:69], v[74:75], v[62:63], v[68:69]
    v_pk_fma_f32 v[70:71], v[72:73], v[62:63], v[70:71] neg_lo:[1,0,0] neg_hi:[1,0,0]
    v_cvt_pk_f16_f32 v96, v68, v69
    v_cvt_pk_f16_f32 v97, v70, v71
    ds_write_b64 v31, v[96:97] offset:29040
    v_pk_mul_f32 v[72:73], v[68:69], v[60:61]
    v_pk_mul_f32 v[74:75], v[70:71], v[60:61]
    v_pk_fma_f32 v[72:73], v[70:71], v[62:63], v[72:73]
    v_pk_fma_f32 v[74:75], v[68:69], v[62:63], v[74:75] neg_lo:[1,0,0] neg_hi:[1,0,0]
    v_cvt_pk_f16_f32 v98, v72, v73
    v_cvt_pk_f16_f32 v99, v74, v75
    ds_write_b64 v31, v[98:99] offset:29568
    v_pk_mul_f32 v[68:69], v[72:73], v[60:61]
    v_pk_mul_f32 v[70:71], v[74:75], v[60:61]
    v_pk_fma_f32 v[68:69], v[74:75], v[62:63], v[68:69]
    v_pk_fma_f32 v[70:71], v[72:73], v[62:63], v[70:71] neg_lo:[1,0,0] neg_hi:[1,0,0]
    v_cvt_pk_f16_f32 v96, v68, v69
    v_cvt_pk_f16_f32 v97, v70, v71
    ds_write_b64 v31, v[96:97] offset:30096
    v_pk_mul_f32 v[72:73], v[68:69], v[60:61]
    v_pk_mul_f32 v[74:75], v[70:71], v[60:61]
    v_pk_fma_f32 v[72:73], v[70:71], v[62:63], v[72:73]
    v_pk_fma_f32 v[74:75], v[68:69], v[62:63], v[74:75] neg_lo:[1,0,0] neg_hi:[1,0,0]
    v_cvt_pk_f16_f32 v98, v72, v73
    v_cvt_pk_f16_f32 v99, v74, v75
    ds_write_b64 v31, v[98:99] offset:30624
    v_mul_f32 v12, s67, v12
    v_lshlrev_b32 v11, 16, v11
    v_cndmask_b32 v11, 0, v11, s[14:15]
    s_waitcnt lgkmcnt(0)
    s_nop 0
    ds_read_b128 v[132:135], v29 offset:0
    ds_read_b128 v[140:143], v29 offset:32
    ds_read_b128 v[148:151], v29 offset:64
    ds_read_b128 v[156:159], v29 offset:96
    ds_read_b128 v[164:167], v29 offset:128
    ds_read_b128 v[172:175], v29 offset:160
    ds_read_b128 v[180:183], v29 offset:192
    ds_read_b128 v[188:191], v29 offset:224
    ds_read_b128 v[196:199], v29 offset:256
    ds_read_b128 v[204:207], v29 offset:288
    ds_read_b128 v[212:215], v29 offset:320
    ds_read_b128 v[220:223], v29 offset:352
    ds_read_b128 v[228:231], v29 offset:384
    ds_read_b128 v[236:239], v29 offset:416
    ds_read_b128 v[244:247], v29 offset:448
    ds_read_b128 v[252:255], v29 offset:480
    s_waitcnt lgkmcnt(0)
    s_barrier
    s_setprio 1
    s_nop 0
    ds_read_b128 v[128:131], v30 offset:0
    ds_read_b128 v[136:139], v30 offset:32
    ds_read_b128 v[144:147], v30 offset:64
    ds_read_b128 v[152:155], v30 offset:96
    ds_read_b128 v[160:163], v30 offset:128
    s_waitcnt lgkmcnt(4)
    v_mfma_f32_32x32x16_f16 v[64:79], v[128:131], v[132:135], 0
    ds_read_b128 v[168:171], v30 offset:160
    s_waitcnt lgkmcnt(4)
    v_mfma_f32_32x32x16_f16 v[64:79], v[136:139], v[140:143], v[64:79]
    ds_read_b128 v[176:179], v30 offset:192
    s_waitcnt lgkmcnt(4)
    v_mfma_f32_32x32x16_f16 v[64:79], v[144:147], v[148:151], v[64:79]
    ds_read_b128 v[184:187], v30 offset:224
    s_waitcnt lgkmcnt(4)
    v_mfma_f32_32x32x16_f16 v[64:79], v[152:155], v[156:159], v[64:79]
    ds_read_b128 v[192:195], v30 offset:256
    s_waitcnt lgkmcnt(4)
    v_mfma_f32_32x32x16_f16 v[64:79], v[160:163], v[164:167], v[64:79]
    ds_read_b128 v[200:203], v30 offset:288
    s_waitcnt lgkmcnt(4)
    v_mfma_f32_32x32x16_f16 v[64:79], v[168:171], v[172:175], v[64:79]
    ds_read_b128 v[208:211], v30 offset:320
    s_waitcnt lgkmcnt(4)
    v_mfma_f32_32x32x16_f16 v[64:79], v[176:179], v[180:183], v[64:79]
    ds_read_b128 v[216:219], v30 offset:352
    s_waitcnt lgkmcnt(4)
    v_mfma_f32_32x32x16_f16 v[64:79], v[184:187], v[188:191], v[64:79]
    ds_read_b128 v[224:227], v30 offset:384
    s_waitcnt lgkmcnt(4)
    v_mfma_f32_32x32x16_f16 v[64:79], v[192:195], v[196:199], v[64:79]
    ds_read_b128 v[232:235], v30 offset:416
    s_waitcnt lgkmcnt(4)
    v_mfma_f32_32x32x16_f16 v[64:79], v[200:203], v[204:207], v[64:79]
    ds_read_b128 v[240:243], v30 offset:448
    s_waitcnt lgkmcnt(4)
    v_mfma_f32_32x32x16_f16 v[64:79], v[208:211], v[212:215], v[64:79]
    ds_read_b128 v[248:251], v30 offset:480
    s_waitcnt lgkmcnt(4)
    v_mfma_f32_32x32x16_f16 v[64:79], v[216:219], v[220:223], v[64:79]
    s_waitcnt lgkmcnt(3)
    v_mfma_f32_32x32x16_f16 v[64:79], v[224:227], v[228:231], v[64:79]
    s_waitcnt lgkmcnt(2)
    v_mfma_f32_32x32x16_f16 v[64:79], v[232:235], v[236:239], v[64:79]
    s_waitcnt lgkmcnt(1)
    v_mfma_f32_32x32x16_f16 v[64:79], v[240:243], v[244:247], v[64:79]
    s_waitcnt lgkmcnt(0)
    v_mfma_f32_32x32x16_f16 v[64:79], v[248:251], v[252:255], v[64:79]
    v_mov_b32_e64 v13, 0
    ds_write_b32 v25, v13
    s_nop 9
    v_fma_f32 v64, v64, v12, v11
    v_mul_f32 v65, v12, v65
    v_mul_f32 v66, v12, v66
    v_mul_f32 v67, v12, v67
    v_mul_f32 v68, v12, v68
    v_mul_f32 v69, v12, v69
    v_mul_f32 v70, v12, v70
    v_mul_f32 v72, v12, v72
    v_mul_f32 v73, v12, v73
    v_mul_f32 v74, v12, v74
    v_mul_f32 v76, v12, v76
    v_mul_f32 v77, v12, v77
    v_mul_f32 v78, v12, v78
    v_mul_f32 v79, v12, v79
    v_cndmask_b32 v13, v76, v77, s[12:13]
    v_cvt_pk_bf16_f32 v80, v76, v76
    v_cvt_pk_bf16_f32 v81, v76, v76
    v_cvt_pk_bf16_f32 v82, v13, v77
    v_cvt_pk_bf16_f32 v83, v77, v77
    v_cvt_pk_bf16_f32 v84, v76, v76
    v_cvt_pk_bf16_f32 v85, v13, v77
    v_cvt_pk_bf16_f32 v86, v77, v77
    v_cvt_pk_bf16_f32 v87, v77, v77
    v_cndmask_b32 v13, v78, v79, s[12:13]
    v_cvt_pk_bf16_f32 v88, v78, v78
    v_cvt_pk_bf16_f32 v89, v78, v78
    v_cvt_pk_bf16_f32 v90, v13, v79
    v_cvt_pk_bf16_f32 v91, v79, v79
    v_cvt_pk_bf16_f32 v92, v78, v78
    v_cvt_pk_bf16_f32 v93, v13, v79
    v_cvt_pk_bf16_f32 v94, v79, v79
    v_cvt_pk_bf16_f32 v95, v79, v79
    v_cvt_pk_bf16_f32 v96, v72, v72
    v_cvt_pk_bf16_f32 v97, v72, v73
    v_cvt_pk_bf16_f32 v98, v73, v73
    v_cvt_pk_bf16_f32 v99, v74, v74
    v_cvt_pk_bf16_f32 v100, v72, v73
    v_cvt_pk_bf16_f32 v101, v73, v73
    v_cvt_pk_bf16_f32 v102, v74, v74
    v_cvt_pk_bf16_f32 v103, v74, v74
    v_cvt_pk_bf16_f32 v104, v64, v65
    v_cvt_pk_bf16_f32 v105, v66, v67
    v_cvt_pk_bf16_f32 v106, v68, v68
    v_cvt_pk_bf16_f32 v107, v69, v70
    v_cvt_pk_bf16_f32 v108, v69, v70
    v_cvt_pk_bf16_f32 v109, v70, v70
    ds_write_b128 v26, v[80:83] offset:2112
    ds_write_b128 v26, v[84:87] offset:6336
    ds_write_b128 v26, v[88:91] offset:2624
    ds_write_b128 v26, v[92:95] offset:6848
    ds_write_b128 v27, v[96:99] offset:1088
    ds_write_b128 v27, v[100:103] offset:5312
    ds_write_b64 v28, v[104:105] offset:64
    ds_write_b64 v28, v[106:107] offset:576
    ds_write_b64 v28, v[108:109] offset:4800
    ds_write_b32 v28, v104 offset:4284
    ds_write_b32 v28, v105 offset:4288
    ds_write_b32 v28, v106 offset:4796
    s_waitcnt lgkmcnt(0)
    s_nop 0
    ds_read_b64 v[128:129], v24 offset:0
    ds_read_b64 v[130:131], v24 offset:8
    ds_read_b64 v[132:133], v24 offset:512
    ds_read_b64 v[134:135], v24 offset:520
    ds_read_b64 v[136:137], v24 offset:1024
    ds_read_b64 v[138:139], v24 offset:1032
    ds_read_b64 v[140:141], v24 offset:1536
    ds_read_b64 v[142:143], v24 offset:1544
    ds_read_b64 v[64:65], v24 offset:2048
    ds_read_b64 v[66:67], v24 offset:2056
    ds_read_b64 v[68:69], v24 offset:2560
    ds_read_b64 v[70:71], v24 offset:2568
    ds_read_b64 v[72:73], v24 offset:3072
    ds_read_b64 v[74:75], v24 offset:3080
    s_barrier
    s_nop 0
    ds_read_b128 v[96:99], v23 offset:3584
    ds_read_b128 v[100:103], v23 offset:3072
    ds_read_b128 v[104:107], v23 offset:2560
    ds_read_b128 v[108:111], v23 offset:2048
    ds_read_b64 v[76:77], v24 offset:3584
    ds_read_b64 v[78:79], v24 offset:3592
    s_waitcnt lgkmcnt(0)
    s_nop 0
    v_mfma_f32_16x16x32_bf16 v[32:35], v[128:131], v[96:99], 0
    v_mfma_f32_16x16x32_bf16 v[36:39], v[128:131], v[100:103], 0
    v_mfma_f32_16x16x32_bf16 v[40:43], v[128:131], v[104:107], 0
    ds_read_b128 v[112:115], v23 offset:3648
    v_mfma_f32_16x16x32_bf16 v[44:47], v[128:131], v[108:111], 0
    ds_read_b128 v[116:119], v23 offset:3136
    v_mfma_f32_16x16x32_bf16 v[36:39], v[132:135], v[96:99], v[36:39]
    ds_read_b128 v[120:123], v23 offset:2624
    v_mfma_f32_16x16x32_bf16 v[40:43], v[132:135], v[100:103], v[40:43]
    ds_read_b128 v[124:127], v23 offset:2112
    v_mfma_f32_16x16x32_bf16 v[44:47], v[132:135], v[104:107], v[44:47]
    ds_read_b64 v[144:145], v24 offset:64
    v_mfma_f32_16x16x32_bf16 v[48:51], v[132:135], v[108:111], 0
    ds_read_b64 v[146:147], v24 offset:72
    v_mfma_f32_16x16x32_bf16 v[40:43], v[136:139], v[96:99], v[40:43]
    ds_read_b64 v[148:149], v24 offset:576
    v_mfma_f32_16x16x32_bf16 v[44:47], v[136:139], v[100:103], v[44:47]
    ds_read_b64 v[150:151], v24 offset:584
    v_mfma_f32_16x16x32_bf16 v[48:51], v[136:139], v[104:107], v[48:51]
    ds_read_b64 v[152:153], v24 offset:1088
    v_mfma_f32_16x16x32_bf16 v[52:55], v[136:139], v[108:111], 0
    ds_read_b64 v[154:155], v24 offset:1096
    v_mfma_f32_16x16x32_bf16 v[44:47], v[140:143], v[96:99], v[44:47]
    ds_read_b64 v[156:157], v24 offset:1600
    v_mfma_f32_16x16x32_bf16 v[48:51], v[140:143], v[100:103], v[48:51]
    ds_read_b64 v[158:159], v24 offset:1608
    v_mfma_f32_16x16x32_bf16 v[52:55], v[140:143], v[104:107], v[52:55]
    ds_read_b64 v[80:81], v24 offset:2112
    v_mfma_f32_16x16x32_bf16 v[56:59], v[140:143], v[108:111], 0
    ds_read_b64 v[82:83], v24 offset:2120
    v_mfma_f32_16x16x32_bf16 v[48:51], v[64:67], v[96:99], v[48:51]
    ds_read_b64 v[84:85], v24 offset:2624
    v_mfma_f32_16x16x32_bf16 v[52:55], v[64:67], v[100:103], v[52:55]
    ds_read_b64 v[86:87], v24 offset:2632
    v_mfma_f32_16x16x32_bf16 v[56:59], v[64:67], v[104:107], v[56:59]
    ds_read_b64 v[88:89], v24 offset:3136
    v_mfma_f32_16x16x32_bf16 v[60:63], v[64:67], v[108:111], 0
    ds_read_b64 v[90:91], v24 offset:3144
    v_mfma_f32_16x16x32_bf16 v[52:55], v[68:71], v[96:99], v[52:55]
    ds_read_b64 v[92:93], v24 offset:3648
    v_mfma_f32_16x16x32_bf16 v[56:59], v[68:71], v[100:103], v[56:59]
    ds_read_b64 v[94:95], v24 offset:3656
    v_mfma_f32_16x16x32_bf16 v[60:63], v[68:71], v[104:107], v[60:63]
    v_mfma_f32_16x16x32_bf16 v[56:59], v[72:75], v[96:99], v[56:59]
    v_mfma_f32_16x16x32_bf16 v[60:63], v[72:75], v[100:103], v[60:63]
    v_mfma_f32_16x16x32_bf16 v[60:63], v[76:79], v[96:99], v[60:63]
    s_waitcnt lgkmcnt(8)
    s_nop 0
    v_mfma_f32_16x16x32_bf16 v[32:35], v[144:147], v[112:115], v[32:35]
    v_mfma_f32_16x16x32_bf16 v[36:39], v[144:147], v[116:119], v[36:39]
    v_mfma_f32_16x16x32_bf16 v[40:43], v[144:147], v[120:123], v[40:43]
    ds_read_b128 v[96:99], v23 offset:3712
    v_mfma_f32_16x16x32_bf16 v[44:47], v[144:147], v[124:127], v[44:47]
    ds_read_b128 v[100:103], v23 offset:3200
    v_mfma_f32_16x16x32_bf16 v[36:39], v[148:151], v[112:115], v[36:39]
    ds_read_b128 v[104:107], v23 offset:2688
    v_mfma_f32_16x16x32_bf16 v[40:43], v[148:151], v[116:119], v[40:43]
    ds_read_b128 v[108:111], v23 offset:2176
    v_mfma_f32_16x16x32_bf16 v[44:47], v[148:151], v[120:123], v[44:47]
    ds_read_b64 v[160:161], v24 offset:128
    v_mfma_f32_16x16x32_bf16 v[48:51], v[148:151], v[124:127], v[48:51]
    ds_read_b64 v[162:163], v24 offset:136
    s_waitcnt lgkmcnt(6)
    s_nop 0
    v_mfma_f32_16x16x32_bf16 v[40:43], v[152:155], v[112:115], v[40:43]
    ds_read_b64 v[164:165], v24 offset:640
    v_mfma_f32_16x16x32_bf16 v[44:47], v[152:155], v[116:119], v[44:47]
    ds_read_b64 v[166:167], v24 offset:648
    v_mfma_f32_16x16x32_bf16 v[48:51], v[152:155], v[120:123], v[48:51]
    ds_read_b64 v[168:169], v24 offset:1152
    v_mfma_f32_16x16x32_bf16 v[52:55], v[152:155], v[124:127], v[52:55]
    ds_read_b64 v[170:171], v24 offset:1160
    v_mfma_f32_16x16x32_bf16 v[44:47], v[156:159], v[112:115], v[44:47]
    ds_read_b64 v[172:173], v24 offset:1664
    v_mfma_f32_16x16x32_bf16 v[48:51], v[156:159], v[116:119], v[48:51]
    ds_read_b64 v[174:175], v24 offset:1672
    v_mfma_f32_16x16x32_bf16 v[52:55], v[156:159], v[120:123], v[52:55]
    ds_read_b64 v[64:65], v24 offset:2176
    v_mfma_f32_16x16x32_bf16 v[56:59], v[156:159], v[124:127], v[56:59]
    ds_read_b64 v[66:67], v24 offset:2184
    v_mfma_f32_16x16x32_bf16 v[48:51], v[80:83], v[112:115], v[48:51]
    ds_read_b64 v[68:69], v24 offset:2688
    v_mfma_f32_16x16x32_bf16 v[52:55], v[80:83], v[116:119], v[52:55]
    ds_read_b64 v[70:71], v24 offset:2696
    v_mfma_f32_16x16x32_bf16 v[56:59], v[80:83], v[120:123], v[56:59]
    ds_read_b64 v[72:73], v24 offset:3200
    v_mfma_f32_16x16x32_bf16 v[60:63], v[80:83], v[124:127], v[60:63]
    ds_read_b64 v[74:75], v24 offset:3208
    v_mfma_f32_16x16x32_bf16 v[52:55], v[84:87], v[112:115], v[52:55]
    ds_read_b64 v[76:77], v24 offset:3712
    v_mfma_f32_16x16x32_bf16 v[56:59], v[84:87], v[116:119], v[56:59]
    ds_read_b64 v[78:79], v24 offset:3720
    v_mfma_f32_16x16x32_bf16 v[60:63], v[84:87], v[120:123], v[60:63]
    v_mfma_f32_16x16x32_bf16 v[56:59], v[88:91], v[112:115], v[56:59]
    v_mfma_f32_16x16x32_bf16 v[60:63], v[88:91], v[116:119], v[60:63]
    v_mfma_f32_16x16x32_bf16 v[60:63], v[92:95], v[112:115], v[60:63]
    s_waitcnt lgkmcnt(8)
    s_nop 0
    v_mfma_f32_16x16x32_bf16 v[32:35], v[160:163], v[96:99], v[32:35]
    v_mfma_f32_16x16x32_bf16 v[36:39], v[160:163], v[100:103], v[36:39]
    v_mfma_f32_16x16x32_bf16 v[40:43], v[160:163], v[104:107], v[40:43]
    ds_read_b128 v[112:115], v23 offset:3776
    v_mfma_f32_16x16x32_bf16 v[44:47], v[160:163], v[108:111], v[44:47]
    ds_read_b128 v[116:119], v23 offset:3264
    v_mfma_f32_16x16x32_bf16 v[36:39], v[164:167], v[96:99], v[36:39]
    ds_read_b128 v[120:123], v23 offset:2752
    v_mfma_f32_16x16x32_bf16 v[40:43], v[164:167], v[100:103], v[40:43]
    ds_read_b128 v[124:127], v23 offset:2240
    v_mfma_f32_16x16x32_bf16 v[44:47], v[164:167], v[104:107], v[44:47]
    ds_read_b64 v[176:177], v24 offset:192
    v_mfma_f32_16x16x32_bf16 v[48:51], v[164:167], v[108:111], v[48:51]
    ds_read_b64 v[178:179], v24 offset:200
    s_waitcnt lgkmcnt(6)
    s_nop 0
    v_mfma_f32_16x16x32_bf16 v[40:43], v[168:171], v[96:99], v[40:43]
    ds_read_b64 v[180:181], v24 offset:704
    v_mfma_f32_16x16x32_bf16 v[44:47], v[168:171], v[100:103], v[44:47]
    ds_read_b64 v[182:183], v24 offset:712
    v_mfma_f32_16x16x32_bf16 v[48:51], v[168:171], v[104:107], v[48:51]
    ds_read_b64 v[184:185], v24 offset:1216
    v_mfma_f32_16x16x32_bf16 v[52:55], v[168:171], v[108:111], v[52:55]
    ds_read_b64 v[186:187], v24 offset:1224
    v_mfma_f32_16x16x32_bf16 v[44:47], v[172:175], v[96:99], v[44:47]
    ds_read_b64 v[188:189], v24 offset:1728
    v_mfma_f32_16x16x32_bf16 v[48:51], v[172:175], v[100:103], v[48:51]
    ds_read_b64 v[190:191], v24 offset:1736
    v_mfma_f32_16x16x32_bf16 v[52:55], v[172:175], v[104:107], v[52:55]
    ds_read_b64 v[80:81], v24 offset:2240
    v_mfma_f32_16x16x32_bf16 v[56:59], v[172:175], v[108:111], v[56:59]
    ds_read_b64 v[82:83], v24 offset:2248
    v_mfma_f32_16x16x32_bf16 v[48:51], v[64:67], v[96:99], v[48:51]
    ds_read_b64 v[84:85], v24 offset:2752
    v_mfma_f32_16x16x32_bf16 v[52:55], v[64:67], v[100:103], v[52:55]
    ds_read_b64 v[86:87], v24 offset:2760
    v_mfma_f32_16x16x32_bf16 v[56:59], v[64:67], v[104:107], v[56:59]
    ds_read_b64 v[88:89], v24 offset:3264
    v_mfma_f32_16x16x32_bf16 v[60:63], v[64:67], v[108:111], v[60:63]
    ds_read_b64 v[90:91], v24 offset:3272
    v_mfma_f32_16x16x32_bf16 v[52:55], v[68:71], v[96:99], v[52:55]
    ds_read_b64 v[92:93], v24 offset:3776
    v_mfma_f32_16x16x32_bf16 v[56:59], v[68:71], v[100:103], v[56:59]
    ds_read_b64 v[94:95], v24 offset:3784
    v_mfma_f32_16x16x32_bf16 v[60:63], v[68:71], v[104:107], v[60:63]
    v_mfma_f32_16x16x32_bf16 v[56:59], v[72:75], v[96:99], v[56:59]
    v_mfma_f32_16x16x32_bf16 v[60:63], v[72:75], v[100:103], v[60:63]
    v_mfma_f32_16x16x32_bf16 v[60:63], v[76:79], v[96:99], v[60:63]
    s_waitcnt lgkmcnt(8)
    s_nop 0
    v_mfma_f32_16x16x32_bf16 v[32:35], v[176:179], v[112:115], v[32:35]
    v_mfma_f32_16x16x32_bf16 v[36:39], v[176:179], v[116:119], v[36:39]
    v_mfma_f32_16x16x32_bf16 v[40:43], v[176:179], v[120:123], v[40:43]
    ds_read_b128 v[96:99], v23 offset:3840
    v_mfma_f32_16x16x32_bf16 v[44:47], v[176:179], v[124:127], v[44:47]
    ds_read_b128 v[100:103], v23 offset:3328
    v_mfma_f32_16x16x32_bf16 v[36:39], v[180:183], v[112:115], v[36:39]
    ds_read_b128 v[104:107], v23 offset:2816
    v_mfma_f32_16x16x32_bf16 v[40:43], v[180:183], v[116:119], v[40:43]
    ds_read_b128 v[108:111], v23 offset:2304
    v_mfma_f32_16x16x32_bf16 v[44:47], v[180:183], v[120:123], v[44:47]
    ds_read_b64 v[192:193], v24 offset:256
    v_mfma_f32_16x16x32_bf16 v[48:51], v[180:183], v[124:127], v[48:51]
    ds_read_b64 v[194:195], v24 offset:264
    s_waitcnt lgkmcnt(6)
    s_nop 0
    v_mfma_f32_16x16x32_bf16 v[40:43], v[184:187], v[112:115], v[40:43]
    ds_read_b64 v[196:197], v24 offset:768
    v_mfma_f32_16x16x32_bf16 v[44:47], v[184:187], v[116:119], v[44:47]
    ds_read_b64 v[198:199], v24 offset:776
    v_mfma_f32_16x16x32_bf16 v[48:51], v[184:187], v[120:123], v[48:51]
    ds_read_b64 v[200:201], v24 offset:1280
    v_mfma_f32_16x16x32_bf16 v[52:55], v[184:187], v[124:127], v[52:55]
    ds_read_b64 v[202:203], v24 offset:1288
    v_mfma_f32_16x16x32_bf16 v[44:47], v[188:191], v[112:115], v[44:47]
    ds_read_b64 v[204:205], v24 offset:1792
    v_mfma_f32_16x16x32_bf16 v[48:51], v[188:191], v[116:119], v[48:51]
    ds_read_b64 v[206:207], v24 offset:1800
    v_mfma_f32_16x16x32_bf16 v[52:55], v[188:191], v[120:123], v[52:55]
    ds_read_b64 v[64:65], v24 offset:2304
    v_mfma_f32_16x16x32_bf16 v[56:59], v[188:191], v[124:127], v[56:59]
    ds_read_b64 v[66:67], v24 offset:2312
    v_mfma_f32_16x16x32_bf16 v[48:51], v[80:83], v[112:115], v[48:51]
    ds_read_b64 v[68:69], v24 offset:2816
    v_mfma_f32_16x16x32_bf16 v[52:55], v[80:83], v[116:119], v[52:55]
    ds_read_b64 v[70:71], v24 offset:2824
    v_mfma_f32_16x16x32_bf16 v[56:59], v[80:83], v[120:123], v[56:59]
    ds_read_b64 v[72:73], v24 offset:3328
    v_mfma_f32_16x16x32_bf16 v[60:63], v[80:83], v[124:127], v[60:63]
    ds_read_b64 v[74:75], v24 offset:3336
    v_mfma_f32_16x16x32_bf16 v[52:55], v[84:87], v[112:115], v[52:55]
    ds_read_b64 v[76:77], v24 offset:3840
    v_mfma_f32_16x16x32_bf16 v[56:59], v[84:87], v[116:119], v[56:59]
    ds_read_b64 v[78:79], v24 offset:3848
    v_mfma_f32_16x16x32_bf16 v[60:63], v[84:87], v[120:123], v[60:63]
    v_mfma_f32_16x16x32_bf16 v[56:59], v[88:91], v[112:115], v[56:59]
    v_mfma_f32_16x16x32_bf16 v[60:63], v[88:91], v[116:119], v[60:63]
    v_mfma_f32_16x16x32_bf16 v[60:63], v[92:95], v[112:115], v[60:63]
    s_waitcnt lgkmcnt(8)
    s_nop 0
    v_mfma_f32_16x16x32_bf16 v[32:35], v[192:195], v[96:99], v[32:35]
    v_mfma_f32_16x16x32_bf16 v[36:39], v[192:195], v[100:103], v[36:39]
    v_mfma_f32_16x16x32_bf16 v[40:43], v[192:195], v[104:107], v[40:43]
    ds_read_b128 v[112:115], v23 offset:3904
    v_mfma_f32_16x16x32_bf16 v[44:47], v[192:195], v[108:111], v[44:47]
    ds_read_b128 v[116:119], v23 offset:3392
    v_mfma_f32_16x16x32_bf16 v[36:39], v[196:199], v[96:99], v[36:39]
    ds_read_b128 v[120:123], v23 offset:2880
    v_mfma_f32_16x16x32_bf16 v[40:43], v[196:199], v[100:103], v[40:43]
    ds_read_b128 v[124:127], v23 offset:2368
    v_mfma_f32_16x16x32_bf16 v[44:47], v[196:199], v[104:107], v[44:47]
    ds_read_b64 v[208:209], v24 offset:320
    v_mfma_f32_16x16x32_bf16 v[48:51], v[196:199], v[108:111], v[48:51]
    ds_read_b64 v[210:211], v24 offset:328
    s_waitcnt lgkmcnt(6)
    s_nop 0
    v_mfma_f32_16x16x32_bf16 v[40:43], v[200:203], v[96:99], v[40:43]
    ds_read_b64 v[212:213], v24 offset:832
    v_mfma_f32_16x16x32_bf16 v[44:47], v[200:203], v[100:103], v[44:47]
    ds_read_b64 v[214:215], v24 offset:840
    v_mfma_f32_16x16x32_bf16 v[48:51], v[200:203], v[104:107], v[48:51]
    ds_read_b64 v[216:217], v24 offset:1344
    v_mfma_f32_16x16x32_bf16 v[52:55], v[200:203], v[108:111], v[52:55]
    ds_read_b64 v[218:219], v24 offset:1352
    v_mfma_f32_16x16x32_bf16 v[44:47], v[204:207], v[96:99], v[44:47]
    ds_read_b64 v[220:221], v24 offset:1856
    v_mfma_f32_16x16x32_bf16 v[48:51], v[204:207], v[100:103], v[48:51]
    ds_read_b64 v[222:223], v24 offset:1864
    v_mfma_f32_16x16x32_bf16 v[52:55], v[204:207], v[104:107], v[52:55]
    ds_read_b64 v[80:81], v24 offset:2368
    v_mfma_f32_16x16x32_bf16 v[56:59], v[204:207], v[108:111], v[56:59]
    ds_read_b64 v[82:83], v24 offset:2376
    v_mfma_f32_16x16x32_bf16 v[48:51], v[64:67], v[96:99], v[48:51]
    ds_read_b64 v[84:85], v24 offset:2880
    v_mfma_f32_16x16x32_bf16 v[52:55], v[64:67], v[100:103], v[52:55]
    ds_read_b64 v[86:87], v24 offset:2888
    v_mfma_f32_16x16x32_bf16 v[56:59], v[64:67], v[104:107], v[56:59]
    ds_read_b64 v[88:89], v24 offset:3392
    v_mfma_f32_16x16x32_bf16 v[60:63], v[64:67], v[108:111], v[60:63]
    ds_read_b64 v[90:91], v24 offset:3400
    v_mfma_f32_16x16x32_bf16 v[52:55], v[68:71], v[96:99], v[52:55]
    ds_read_b64 v[92:93], v24 offset:3904
    v_mfma_f32_16x16x32_bf16 v[56:59], v[68:71], v[100:103], v[56:59]
    ds_read_b64 v[94:95], v24 offset:3912
    v_mfma_f32_16x16x32_bf16 v[60:63], v[68:71], v[104:107], v[60:63]
    v_mfma_f32_16x16x32_bf16 v[56:59], v[72:75], v[96:99], v[56:59]
    v_mfma_f32_16x16x32_bf16 v[60:63], v[72:75], v[100:103], v[60:63]
    v_mfma_f32_16x16x32_bf16 v[60:63], v[76:79], v[96:99], v[60:63]
    s_waitcnt lgkmcnt(8)
    s_nop 0
    v_mfma_f32_16x16x32_bf16 v[32:35], v[208:211], v[112:115], v[32:35]
    v_mfma_f32_16x16x32_bf16 v[36:39], v[208:211], v[116:119], v[36:39]
    v_mfma_f32_16x16x32_bf16 v[40:43], v[208:211], v[120:123], v[40:43]
    ds_read_b128 v[96:99], v23 offset:3968
    v_mfma_f32_16x16x32_bf16 v[44:47], v[208:211], v[124:127], v[44:47]
    ds_read_b128 v[100:103], v23 offset:3456
    v_mfma_f32_16x16x32_bf16 v[36:39], v[212:215], v[112:115], v[36:39]
    ds_read_b128 v[104:107], v23 offset:2944
    v_mfma_f32_16x16x32_bf16 v[40:43], v[212:215], v[116:119], v[40:43]
    ds_read_b128 v[108:111], v23 offset:2432
    v_mfma_f32_16x16x32_bf16 v[44:47], v[212:215], v[120:123], v[44:47]
    ds_read_b64 v[224:225], v24 offset:384
    v_mfma_f32_16x16x32_bf16 v[48:51], v[212:215], v[124:127], v[48:51]
    ds_read_b64 v[226:227], v24 offset:392
    s_waitcnt lgkmcnt(6)
    s_nop 0
    v_mfma_f32_16x16x32_bf16 v[40:43], v[216:219], v[112:115], v[40:43]
    ds_read_b64 v[228:229], v24 offset:896
    v_mfma_f32_16x16x32_bf16 v[44:47], v[216:219], v[116:119], v[44:47]
    ds_read_b64 v[230:231], v24 offset:904
    v_mfma_f32_16x16x32_bf16 v[48:51], v[216:219], v[120:123], v[48:51]
    ds_read_b64 v[232:233], v24 offset:1408
    v_mfma_f32_16x16x32_bf16 v[52:55], v[216:219], v[124:127], v[52:55]
    ds_read_b64 v[234:235], v24 offset:1416
    v_mfma_f32_16x16x32_bf16 v[44:47], v[220:223], v[112:115], v[44:47]
    ds_read_b64 v[236:237], v24 offset:1920
    v_mfma_f32_16x16x32_bf16 v[48:51], v[220:223], v[116:119], v[48:51]
    ds_read_b64 v[238:239], v24 offset:1928
    v_mfma_f32_16x16x32_bf16 v[52:55], v[220:223], v[120:123], v[52:55]
    ds_read_b64 v[64:65], v24 offset:2432
    v_mfma_f32_16x16x32_bf16 v[56:59], v[220:223], v[124:127], v[56:59]
    ds_read_b64 v[66:67], v24 offset:2440
    v_mfma_f32_16x16x32_bf16 v[48:51], v[80:83], v[112:115], v[48:51]
    ds_read_b64 v[68:69], v24 offset:2944
    v_mfma_f32_16x16x32_bf16 v[52:55], v[80:83], v[116:119], v[52:55]
    ds_read_b64 v[70:71], v24 offset:2952
    v_mfma_f32_16x16x32_bf16 v[56:59], v[80:83], v[120:123], v[56:59]
    ds_read_b64 v[72:73], v24 offset:3456
    v_mfma_f32_16x16x32_bf16 v[60:63], v[80:83], v[124:127], v[60:63]
    ds_read_b64 v[74:75], v24 offset:3464
    v_mfma_f32_16x16x32_bf16 v[52:55], v[84:87], v[112:115], v[52:55]
    ds_read_b64 v[76:77], v24 offset:3968
    v_mfma_f32_16x16x32_bf16 v[56:59], v[84:87], v[116:119], v[56:59]
    ds_read_b64 v[78:79], v24 offset:3976
    v_mfma_f32_16x16x32_bf16 v[60:63], v[84:87], v[120:123], v[60:63]
    v_mfma_f32_16x16x32_bf16 v[56:59], v[88:91], v[112:115], v[56:59]
    v_mfma_f32_16x16x32_bf16 v[60:63], v[88:91], v[116:119], v[60:63]
    v_mfma_f32_16x16x32_bf16 v[60:63], v[92:95], v[112:115], v[60:63]
    s_waitcnt lgkmcnt(8)
    s_nop 0
    v_mfma_f32_16x16x32_bf16 v[32:35], v[224:227], v[96:99], v[32:35]
    v_mfma_f32_16x16x32_bf16 v[36:39], v[224:227], v[100:103], v[36:39]
    v_mfma_f32_16x16x32_bf16 v[40:43], v[224:227], v[104:107], v[40:43]
    ds_read_b128 v[112:115], v23 offset:4032
    v_mfma_f32_16x16x32_bf16 v[44:47], v[224:227], v[108:111], v[44:47]
    ds_read_b128 v[116:119], v23 offset:3520
    v_mfma_f32_16x16x32_bf16 v[36:39], v[228:231], v[96:99], v[36:39]
    ds_read_b128 v[120:123], v23 offset:3008
    v_mfma_f32_16x16x32_bf16 v[40:43], v[228:231], v[100:103], v[40:43]
    ds_read_b128 v[124:127], v23 offset:2496
    v_mfma_f32_16x16x32_bf16 v[44:47], v[228:231], v[104:107], v[44:47]
    ds_read_b64 v[240:241], v24 offset:448
    v_mfma_f32_16x16x32_bf16 v[48:51], v[228:231], v[108:111], v[48:51]
    ds_read_b64 v[242:243], v24 offset:456
    s_waitcnt lgkmcnt(6)
    s_nop 0
    v_mfma_f32_16x16x32_bf16 v[40:43], v[232:235], v[96:99], v[40:43]
    ds_read_b64 v[244:245], v24 offset:960
    v_mfma_f32_16x16x32_bf16 v[44:47], v[232:235], v[100:103], v[44:47]
    ds_read_b64 v[246:247], v24 offset:968
    v_mfma_f32_16x16x32_bf16 v[48:51], v[232:235], v[104:107], v[48:51]
    ds_read_b64 v[248:249], v24 offset:1472
    v_mfma_f32_16x16x32_bf16 v[52:55], v[232:235], v[108:111], v[52:55]
    ds_read_b64 v[250:251], v24 offset:1480
    v_mfma_f32_16x16x32_bf16 v[44:47], v[236:239], v[96:99], v[44:47]
    ds_read_b64 v[252:253], v24 offset:1984
    v_mfma_f32_16x16x32_bf16 v[48:51], v[236:239], v[100:103], v[48:51]
    ds_read_b64 v[254:255], v24 offset:1992
    v_mfma_f32_16x16x32_bf16 v[52:55], v[236:239], v[104:107], v[52:55]
    ds_read_b64 v[80:81], v24 offset:2496
    v_mfma_f32_16x16x32_bf16 v[56:59], v[236:239], v[108:111], v[56:59]
    ds_read_b64 v[82:83], v24 offset:2504
    v_mfma_f32_16x16x32_bf16 v[48:51], v[64:67], v[96:99], v[48:51]
    ds_read_b64 v[84:85], v24 offset:3008
    v_mfma_f32_16x16x32_bf16 v[52:55], v[64:67], v[100:103], v[52:55]
    ds_read_b64 v[86:87], v24 offset:3016
    v_mfma_f32_16x16x32_bf16 v[56:59], v[64:67], v[104:107], v[56:59]
    ds_read_b64 v[88:89], v24 offset:3520
    v_mfma_f32_16x16x32_bf16 v[60:63], v[64:67], v[108:111], v[60:63]
    ds_read_b64 v[90:91], v24 offset:3528
    v_mfma_f32_16x16x32_bf16 v[52:55], v[68:71], v[96:99], v[52:55]
    ds_read_b64 v[92:93], v24 offset:4032
    v_mfma_f32_16x16x32_bf16 v[56:59], v[68:71], v[100:103], v[56:59]
    ds_read_b64 v[94:95], v24 offset:4040
    v_mfma_f32_16x16x32_bf16 v[60:63], v[68:71], v[104:107], v[60:63]
    v_mfma_f32_16x16x32_bf16 v[56:59], v[72:75], v[96:99], v[56:59]
    v_mfma_f32_16x16x32_bf16 v[60:63], v[72:75], v[100:103], v[60:63]
    v_mfma_f32_16x16x32_bf16 v[60:63], v[76:79], v[96:99], v[60:63]
    s_waitcnt lgkmcnt(8)
    s_nop 0
    v_mfma_f32_16x16x32_bf16 v[32:35], v[240:243], v[112:115], v[32:35]
    v_mfma_f32_16x16x32_bf16 v[36:39], v[240:243], v[116:119], v[36:39]
    v_mfma_f32_16x16x32_bf16 v[40:43], v[240:243], v[120:123], v[40:43]
    v_mfma_f32_16x16x32_bf16 v[44:47], v[240:243], v[124:127], v[44:47]
    v_mfma_f32_16x16x32_bf16 v[36:39], v[244:247], v[112:115], v[36:39]
    v_mfma_f32_16x16x32_bf16 v[40:43], v[244:247], v[116:119], v[40:43]
    v_mfma_f32_16x16x32_bf16 v[44:47], v[244:247], v[120:123], v[44:47]
    v_mfma_f32_16x16x32_bf16 v[48:51], v[244:247], v[124:127], v[48:51]
    s_waitcnt lgkmcnt(0)
    s_nop 0
    v_mfma_f32_16x16x32_bf16 v[40:43], v[248:251], v[112:115], v[40:43]
    v_mfma_f32_16x16x32_bf16 v[44:47], v[248:251], v[116:119], v[44:47]
    v_mfma_f32_16x16x32_bf16 v[48:51], v[248:251], v[120:123], v[48:51]
    v_mfma_f32_16x16x32_bf16 v[52:55], v[248:251], v[124:127], v[52:55]
    v_mfma_f32_16x16x32_bf16 v[44:47], v[252:255], v[112:115], v[44:47]
    v_mfma_f32_16x16x32_bf16 v[48:51], v[252:255], v[116:119], v[48:51]
    v_mfma_f32_16x16x32_bf16 v[52:55], v[252:255], v[120:123], v[52:55]
    v_mfma_f32_16x16x32_bf16 v[56:59], v[252:255], v[124:127], v[56:59]
    v_mfma_f32_16x16x32_bf16 v[48:51], v[80:83], v[112:115], v[48:51]
    v_mfma_f32_16x16x32_bf16 v[52:55], v[80:83], v[116:119], v[52:55]
    v_mfma_f32_16x16x32_bf16 v[56:59], v[80:83], v[120:123], v[56:59]
    v_mfma_f32_16x16x32_bf16 v[60:63], v[80:83], v[124:127], v[60:63]
    s_barrier
    s_nop 0
    v_mfma_f32_16x16x32_bf16 v[52:55], v[84:87], v[112:115], v[52:55]
    ds_read_b128 v[96:99], v23 offset:1536
    v_mfma_f32_16x16x32_bf16 v[56:59], v[84:87], v[116:119], v[56:59]
    ds_read_b128 v[100:103], v23 offset:1024
    v_mfma_f32_16x16x32_bf16 v[60:63], v[84:87], v[120:123], v[60:63]
    ds_read_b128 v[104:107], v23 offset:512
    v_mfma_f32_16x16x32_bf16 v[56:59], v[88:91], v[112:115], v[56:59]
    ds_read_b128 v[108:111], v23 offset:0
    v_mfma_f32_16x16x32_bf16 v[60:63], v[88:91], v[116:119], v[60:63]
    v_mfma_f32_16x16x32_bf16 v[60:63], v[92:95], v[112:115], v[60:63]
    s_waitcnt lgkmcnt(0)
    s_nop 0
    v_mfma_f32_16x16x32_bf16 v[48:51], v[128:131], v[96:99], v[48:51]
    ds_read_b128 v[112:115], v23 offset:1600
    v_mfma_f32_16x16x32_bf16 v[52:55], v[128:131], v[100:103], v[52:55]
    ds_read_b128 v[116:119], v23 offset:1088
    v_mfma_f32_16x16x32_bf16 v[56:59], v[128:131], v[104:107], v[56:59]
    ds_read_b128 v[120:123], v23 offset:576
    v_mfma_f32_16x16x32_bf16 v[60:63], v[128:131], v[108:111], v[60:63]
    ds_read_b128 v[124:127], v23 offset:64
    v_mfma_f32_16x16x32_bf16 v[52:55], v[132:135], v[96:99], v[52:55]
    v_mfma_f32_16x16x32_bf16 v[56:59], v[132:135], v[100:103], v[56:59]
    v_mfma_f32_16x16x32_bf16 v[60:63], v[132:135], v[104:107], v[60:63]
    v_mfma_f32_16x16x32_bf16 v[56:59], v[136:139], v[96:99], v[56:59]
    v_mfma_f32_16x16x32_bf16 v[60:63], v[136:139], v[100:103], v[60:63]
    v_mfma_f32_16x16x32_bf16 v[60:63], v[140:143], v[96:99], v[60:63]
    s_waitcnt lgkmcnt(0)
    s_nop 0
    v_mfma_f32_16x16x32_bf16 v[48:51], v[144:147], v[112:115], v[48:51]
    ds_read_b128 v[96:99], v23 offset:1664
    v_mfma_f32_16x16x32_bf16 v[52:55], v[144:147], v[116:119], v[52:55]
    ds_read_b128 v[100:103], v23 offset:1152
    v_mfma_f32_16x16x32_bf16 v[56:59], v[144:147], v[120:123], v[56:59]
    ds_read_b128 v[104:107], v23 offset:640
    v_mfma_f32_16x16x32_bf16 v[60:63], v[144:147], v[124:127], v[60:63]
    ds_read_b128 v[108:111], v23 offset:128
    v_mfma_f32_16x16x32_bf16 v[52:55], v[148:151], v[112:115], v[52:55]
    v_cvt_pk_bf16_f32 v4, v32, v33
    v_mfma_f32_16x16x32_bf16 v[56:59], v[148:151], v[116:119], v[56:59]
    v_cvt_pk_bf16_f32 v5, v34, v35
    v_mfma_f32_16x16x32_bf16 v[60:63], v[148:151], v[120:123], v[60:63]
    v_cvt_pk_bf16_f32 v6, v36, v37
    v_mfma_f32_16x16x32_bf16 v[56:59], v[152:155], v[112:115], v[56:59]
    v_cvt_pk_bf16_f32 v7, v38, v39
    v_mfma_f32_16x16x32_bf16 v[60:63], v[152:155], v[116:119], v[60:63]
    buffer_store_dwordx4 v[4:7], v22, s[56:59], s9 offen offset:0 sc1
    v_mfma_f32_16x16x32_bf16 v[60:63], v[156:159], v[112:115], v[60:63]
    s_waitcnt lgkmcnt(0)
    s_nop 0
    v_mfma_f32_16x16x32_bf16 v[48:51], v[160:163], v[96:99], v[48:51]
    ds_read_b128 v[112:115], v23 offset:1728
    v_mfma_f32_16x16x32_bf16 v[52:55], v[160:163], v[100:103], v[52:55]
    ds_read_b128 v[116:119], v23 offset:1216
    v_mfma_f32_16x16x32_bf16 v[56:59], v[160:163], v[104:107], v[56:59]
    ds_read_b128 v[120:123], v23 offset:704
    v_mfma_f32_16x16x32_bf16 v[60:63], v[160:163], v[108:111], v[60:63]
    ds_read_b128 v[124:127], v23 offset:192
    v_mfma_f32_16x16x32_bf16 v[52:55], v[164:167], v[96:99], v[52:55]
    v_cvt_pk_bf16_f32 v8, v40, v41
    v_mfma_f32_16x16x32_bf16 v[56:59], v[164:167], v[100:103], v[56:59]
    v_cvt_pk_bf16_f32 v9, v42, v43
    v_mfma_f32_16x16x32_bf16 v[60:63], v[164:167], v[104:107], v[60:63]
    v_cvt_pk_bf16_f32 v10, v44, v45
    v_mfma_f32_16x16x32_bf16 v[56:59], v[168:171], v[96:99], v[56:59]
    v_cvt_pk_bf16_f32 v11, v46, v47
    v_mfma_f32_16x16x32_bf16 v[60:63], v[168:171], v[100:103], v[60:63]
    buffer_store_dwordx4 v[8:11], v22, s[56:59], s9 offen offset:1024 sc1
    v_mfma_f32_16x16x32_bf16 v[60:63], v[172:175], v[96:99], v[60:63]
    s_waitcnt lgkmcnt(0)
    s_nop 0
    v_mfma_f32_16x16x32_bf16 v[48:51], v[176:179], v[112:115], v[48:51]
    ds_read_b128 v[96:99], v23 offset:1792
    v_mfma_f32_16x16x32_bf16 v[52:55], v[176:179], v[116:119], v[52:55]
    ds_read_b128 v[100:103], v23 offset:1280
    v_mfma_f32_16x16x32_bf16 v[56:59], v[176:179], v[120:123], v[56:59]
    ds_read_b128 v[104:107], v23 offset:768
    v_mfma_f32_16x16x32_bf16 v[60:63], v[176:179], v[124:127], v[60:63]
    ds_read_b128 v[108:111], v23 offset:256
    v_mfma_f32_16x16x32_bf16 v[52:55], v[180:183], v[112:115], v[52:55]
    v_mfma_f32_16x16x32_bf16 v[56:59], v[180:183], v[116:119], v[56:59]
    v_mfma_f32_16x16x32_bf16 v[60:63], v[180:183], v[120:123], v[60:63]
    v_mfma_f32_16x16x32_bf16 v[56:59], v[184:187], v[112:115], v[56:59]
    v_mfma_f32_16x16x32_bf16 v[60:63], v[184:187], v[116:119], v[60:63]
    v_mfma_f32_16x16x32_bf16 v[60:63], v[188:191], v[112:115], v[60:63]
    s_waitcnt lgkmcnt(0)
    s_nop 0
    v_mfma_f32_16x16x32_bf16 v[48:51], v[192:195], v[96:99], v[48:51]
    ds_read_b128 v[112:115], v23 offset:1856
    v_mfma_f32_16x16x32_bf16 v[52:55], v[192:195], v[100:103], v[52:55]
    ds_read_b128 v[116:119], v23 offset:1344
    v_mfma_f32_16x16x32_bf16 v[56:59], v[192:195], v[104:107], v[56:59]
    ds_read_b128 v[120:123], v23 offset:832
    v_mfma_f32_16x16x32_bf16 v[60:63], v[192:195], v[108:111], v[60:63]
    ds_read_b128 v[124:127], v23 offset:320
    v_mfma_f32_16x16x32_bf16 v[52:55], v[196:199], v[96:99], v[52:55]
    v_mfma_f32_16x16x32_bf16 v[56:59], v[196:199], v[100:103], v[56:59]
    v_mfma_f32_16x16x32_bf16 v[60:63], v[196:199], v[104:107], v[60:63]
    v_mfma_f32_16x16x32_bf16 v[56:59], v[200:203], v[96:99], v[56:59]
    v_mfma_f32_16x16x32_bf16 v[60:63], v[200:203], v[100:103], v[60:63]
    v_mfma_f32_16x16x32_bf16 v[60:63], v[204:207], v[96:99], v[60:63]
    s_waitcnt lgkmcnt(0)
    s_nop 0
    v_mfma_f32_16x16x32_bf16 v[48:51], v[208:211], v[112:115], v[48:51]
    ds_read_b128 v[96:99], v23 offset:1920
    v_mfma_f32_16x16x32_bf16 v[52:55], v[208:211], v[116:119], v[52:55]
    ds_read_b128 v[100:103], v23 offset:1408
    v_mfma_f32_16x16x32_bf16 v[56:59], v[208:211], v[120:123], v[56:59]
    ds_read_b128 v[104:107], v23 offset:896
    v_mfma_f32_16x16x32_bf16 v[60:63], v[208:211], v[124:127], v[60:63]
    ds_read_b128 v[108:111], v23 offset:384
    v_mfma_f32_16x16x32_bf16 v[52:55], v[212:215], v[112:115], v[52:55]
    v_mfma_f32_16x16x32_bf16 v[56:59], v[212:215], v[116:119], v[56:59]
    v_mfma_f32_16x16x32_bf16 v[60:63], v[212:215], v[120:123], v[60:63]
    v_mfma_f32_16x16x32_bf16 v[56:59], v[216:219], v[112:115], v[56:59]
    v_mfma_f32_16x16x32_bf16 v[60:63], v[216:219], v[116:119], v[60:63]
    v_mfma_f32_16x16x32_bf16 v[60:63], v[220:223], v[112:115], v[60:63]
    s_waitcnt lgkmcnt(0)
    s_nop 0
    v_mfma_f32_16x16x32_bf16 v[48:51], v[224:227], v[96:99], v[48:51]
    ds_read_b128 v[112:115], v23 offset:1984
    v_mfma_f32_16x16x32_bf16 v[52:55], v[224:227], v[100:103], v[52:55]
    ds_read_b128 v[116:119], v23 offset:1472
    v_mfma_f32_16x16x32_bf16 v[56:59], v[224:227], v[104:107], v[56:59]
    ds_read_b128 v[120:123], v23 offset:960
    v_mfma_f32_16x16x32_bf16 v[60:63], v[224:227], v[108:111], v[60:63]
    ds_read_b128 v[124:127], v23 offset:448
    v_mfma_f32_16x16x32_bf16 v[52:55], v[228:231], v[96:99], v[52:55]
    v_mfma_f32_16x16x32_bf16 v[56:59], v[228:231], v[100:103], v[56:59]
    v_mfma_f32_16x16x32_bf16 v[60:63], v[228:231], v[104:107], v[60:63]
    v_mfma_f32_16x16x32_bf16 v[56:59], v[232:235], v[96:99], v[56:59]
    v_mfma_f32_16x16x32_bf16 v[60:63], v[232:235], v[100:103], v[60:63]
    v_mfma_f32_16x16x32_bf16 v[60:63], v[236:239], v[96:99], v[60:63]
    s_waitcnt lgkmcnt(0)
    s_nop 0
    v_mfma_f32_16x16x32_bf16 v[48:51], v[240:243], v[112:115], v[48:51]
    v_mfma_f32_16x16x32_bf16 v[52:55], v[240:243], v[116:119], v[52:55]
    v_mfma_f32_16x16x32_bf16 v[56:59], v[240:243], v[120:123], v[56:59]
    v_mfma_f32_16x16x32_bf16 v[60:63], v[240:243], v[124:127], v[60:63]
    v_mfma_f32_16x16x32_bf16 v[52:55], v[244:247], v[112:115], v[52:55]
    v_mfma_f32_16x16x32_bf16 v[56:59], v[244:247], v[116:119], v[56:59]
    v_mfma_f32_16x16x32_bf16 v[60:63], v[244:247], v[120:123], v[60:63]
    v_mfma_f32_16x16x32_bf16 v[56:59], v[248:251], v[112:115], v[56:59]
    v_mfma_f32_16x16x32_bf16 v[60:63], v[248:251], v[116:119], v[60:63]
    v_mfma_f32_16x16x32_bf16 v[60:63], v[252:255], v[112:115], v[60:63]
    v_cvt_pk_bf16_f32 v12, v48, v49
    v_cvt_pk_bf16_f32 v13, v50, v51
    s_nop 0
    s_nop 0
    v_cvt_pk_bf16_f32 v14, v52, v53
    v_cvt_pk_bf16_f32 v15, v54, v55
    buffer_store_dwordx4 v[12:15], v22, s[56:59], s9 offen offset:2048 sc1
    v_cvt_pk_bf16_f32 v16, v56, v57
    v_cvt_pk_bf16_f32 v17, v58, v59
    v_cvt_pk_bf16_f32 v18, v60, v61
    v_cvt_pk_bf16_f32 v19, v62, v63
    buffer_store_dwordx4 v[16:19], v22, s[56:59], s9 offen offset:3072 sc1
    s_setprio 0
    s_mov_b32 s24, 1
    s_branch L_p2comp
.p2align 3
L_cload:
    s_lshl_b32 s11, s10, 18
    s_lshl_b32 s12, s7, 3
    s_add_u32 s11, s11, s12
    v_lshl_add_u32 v130, v0, 12, s11
    s_sub_u32 s13, s11, 1024
    v_mov_b32 v131, s13
    s_add_u32 s13, s13, 0x100000
    v_mov_b32_e64 v132, s13
    s_mov_b32 s14, 0x100000
    s_lshl_b32 s9, s5, 2
    s_add_u32 s9, s9, s10
    s_mov_b32 s48, s16
    s_mov_b32 s49, s17
    s_mov_b32 s50, 2097152
    s_mov_b32 s51, 0x20000
    s_mov_b32 s52, s18
    s_mov_b32 s53, s19
    s_mov_b32 s54, 1572864
    s_mov_b32 s55, 0x20000
    s_sleep 4
    v_lshrrev_b32 v141, 4, v0
    v_mul_u32_u24 v141, 196608, v141
    v_bfe_u32 v143, v0, 2, 2
    v_min_u32_e64 v143, 2, v143
    v_lshl_add_u32 v141, v143, 10, v141
    v_and_b32_e64 v143, 3, v0
    v_lshl_add_u32 v141, v143, 7, v141
    s_mul_i32 s65, s9, 3072
    s_lshr_b32 s66, s4, 2
    s_lshl_b32 s66, s66, 9
    s_add_u32 s65, s65, s66
    v_add_u32 v141, s65, v141
    s_mov_b32 s15, 786432
    s_mov_b32 s64, 196608
    buffer_load_dword v152, v141, s[52:55], s64 offen
    s_sleep 4
    v_and_b32_e64 v142, 31, v0
    s_lshl_b32 s65, s9, 15
    s_lshl_b32 s66, s4, 7
    s_add_u32 s65, s65, s66
    v_lshl_add_u32 v142, v142, 10, s65
    buffer_load_dword v150, v142, s[48:51], 0 offen
    v_lshrrev_b32 v144, 2, v0
    v_min_u32 v144, 7, v144
    v_mul_u32_u24 v144, 196608, v144
    v_and_b32 v143, 3, v0
    v_min_u32 v143, 2, v143
    v_lshl_add_u32 v144, v143, 7, v144
    s_mul_i32 s65, s8, 384
    v_add_u32_e64 v144, s65, v144
    buffer_load_dword v154, v144, s[52:55], 0 offen
    v_and_b32 v146, 7, v0
    s_lshl_b32 s65, s8, 10
    v_lshl_add_u32 v146, v146, 7, s65
    global_load_dword v156, v146, s[20:21]
    s_mov_b32 s56, s46
    s_mov_b32 s57, s47
    s_mov_b32 s58, 6291456
    s_mov_b32 s59, 0x20000
    s_mov_b32 s60, s44
    s_mov_b32 s61, s45
    s_mov_b32 s62, 256
    s_mov_b32 s63, 0x20000
    s_mov_b32 s0, 8448
    s_mov_b32 s1, 31232
    s_mov_b32 s23, 124928
    s_mov_b32 s22, 24832
    s_mov_b32 s73, 31232
    s_mov_b32 s75, 161536
    s_lshl_b32 s64, s7, 7
    s_add_u32 s74, s64, 4308992
    v_and_b32 v14, 31, v0
    v_min_u32 v14, 27, v14
    v_lshrrev_b32 v15, 5, v0
    v_mul_u32_u24 v15, 4576, v15
    v_lshl_add_u32 v14, v14, 4, v15
    s_mul_i32 s66, s10, 9152
    s_add_u32 s66, s66, 129024
    v_add_u32 v14, s66, v14
    v_mov_b32 v16, 0
    v_mov_b32 v17, 0
    v_mov_b32 v18, 0
    v_mov_b32_e64 v19, 0
    ds_write_b128 v14, v[16:19]
    s_lshl_b32 s66, s10, 9
    s_sub_u32 s66, 126968, s66
    v_lshlrev_b32 v133, 3, v0
    v_sub_u32_e64 v133, s66, v133
    s_mov_b32 s68, 0x05040100
    s_mov_b32 s69, 0x07060302
    s_mov_b32 s71, 1042479491
    s_mov_b32 s72, 0x43800000
    v_mov_b32 v96, 0x3c003c00
    v_mov_b32 v97, 0
    ds_write_b64 v31, v[96:97]
    s_setprio 1
    s_waitcnt vmcnt(4)
    v_lshlrev_b32 v10, 16, v10
    v_mul_f32 v10, s70, v10
    v_exp_f32 v10, v10
    v_lshlrev_b32 v32, 16, v4
    v_and_b32 v33, 0xffff0000, v4
    v_lshlrev_b32_e64 v34, 16, v5
    v_and_b32 v35, 0xffff0000, v5
    v_cvt_pk_bf16_f32 v10, v10, v10
    v_and_b32 v12, 0xffff0000, v10
    v_mul_f32 v32, v12, v32
    v_mul_f32 v33, v12, v33
    v_mul_f32 v34, v12, v34
    v_mul_f32 v35, v12, v35
    v_mul_f32 v32, s70, v32
    v_mul_f32 v33, s70, v33
    v_mul_f32 v34, s71, v34
    v_mul_f32 v35, s71, v35
    v_rndne_f32 v84, v34
    v_rndne_f32 v85, v35
    v_exp_f32 v86, v32
    v_exp_f32 v87, v33
    v_sub_f32 v84, v34, v84
    v_sub_f32 v85, v35, v85
    v_cos_f32 v48, v84
    v_cos_f32 v49, v85
    v_sin_f32 v50, v84
    v_sin_f32 v51, v85
    v_pk_mul_f32 v[48:49], v[48:49], v[86:87]
    v_pk_mul_f32 v[50:51], v[50:51], v[86:87]
    v_mul_f32 v80, s72, v32
    v_mul_f32 v82, s72, v34
    v_mul_f32 v81, s72, v33
    v_mul_f32 v83, s72, v35
    v_rndne_f32 v84, v82
    v_rndne_f32 v85, v83
    v_exp_f32 v86, v80
    v_exp_f32 v87, v81
    v_sub_f32 v84, v82, v84
    v_sub_f32 v85, v83, v85
    v_cos_f32 v64, v84
    v_cos_f32 v65, v85
    v_sin_f32 v66, v84
    v_sin_f32 v67, v85
    v_pk_mul_f32 v[64:65], v[64:65], v[86:87]
    v_pk_mul_f32 v[66:67], v[66:67], v[86:87]
    v_cvt_pk_f16_f32 v98, v48, v49
    v_cvt_pk_f16_f32 v99, v50, v51
    ds_write_b64 v31, v[98:99] offset:528
    v_pk_mul_f32 v[52:53], v[48:49], v[48:49]
    v_pk_mul_f32 v[54:55], v[50:51], v[48:49]
    v_pk_fma_f32 v[52:53], v[50:51], v[50:51], v[52:53] neg_lo:[1,0,0] neg_hi:[1,0,0]
    v_pk_fma_f32 v[54:55], v[48:49], v[50:51], v[54:55]
    v_cvt_pk_f16_f32 v96, v52, v53
    v_cvt_pk_f16_f32 v97, v54, v55
    ds_write_b64 v31, v[96:97] offset:1056
    v_pk_mul_f32 v[68:69], v[52:53], v[48:49]
    v_pk_mul_f32 v[70:71], v[54:55], v[48:49]
    v_pk_fma_f32 v[68:69], v[54:55], v[50:51], v[68:69] neg_lo:[1,0,0] neg_hi:[1,0,0]
    v_pk_fma_f32 v[70:71], v[52:53], v[50:51], v[70:71]
    v_cvt_pk_f16_f32 v98, v68, v69
    v_cvt_pk_f16_f32 v99, v70, v71
    ds_write_b64 v31, v[98:99] offset:1584
    v_pk_mul_f32 v[56:57], v[52:53], v[52:53]
    v_pk_mul_f32 v[58:59], v[54:55], v[52:53]
    v_pk_fma_f32 v[56:57], v[54:55], v[54:55], v[56:57] neg_lo:[1,0,0] neg_hi:[1,0,0]
    v_pk_fma_f32 v[58:59], v[52:53], v[54:55], v[58:59]
    v_cvt_pk_f16_f32 v96, v56, v57
    v_cvt_pk_f16_f32 v97, v58, v59
    ds_write_b64 v31, v[96:97] offset:2112
    buffer_load_dwordx2 v[110:111], v131, s[48:51], 0 offen
    buffer_load_dwordx2 v[112:113], v130, s[48:51], 0 offen offset:0
    v_pk_mul_f32 v[68:69], v[56:57], v[48:49]
    v_pk_mul_f32 v[70:71], v[58:59], v[48:49]
    v_pk_fma_f32 v[68:69], v[58:59], v[50:51], v[68:69] neg_lo:[1,0,0] neg_hi:[1,0,0]
    v_pk_fma_f32 v[70:71], v[56:57], v[50:51], v[70:71]
    v_cvt_pk_f16_f32 v98, v68, v69
    v_cvt_pk_f16_f32 v99, v70, v71
    ds_write_b64 v31, v[98:99] offset:2640
    v_pk_mul_f32 v[72:73], v[56:57], v[52:53]
    v_pk_mul_f32 v[74:75], v[58:59], v[52:53]
    v_pk_fma_f32 v[72:73], v[58:59], v[54:55], v[72:73] neg_lo:[1,0,0] neg_hi:[1,0,0]
    v_pk_fma_f32 v[74:75], v[56:57], v[54:55], v[74:75]
    v_cvt_pk_f16_f32 v96, v72, v73
    v_cvt_pk_f16_f32 v97, v74, v75
    ds_write_b64 v31, v[96:97] offset:3168
    v_pk_mul_f32 v[68:69], v[72:73], v[48:49]
    v_pk_mul_f32 v[70:71], v[74:75], v[48:49]
    v_pk_fma_f32 v[68:69], v[74:75], v[50:51], v[68:69] neg_lo:[1,0,0] neg_hi:[1,0,0]
    v_pk_fma_f32 v[70:71], v[72:73], v[50:51], v[70:71]
    v_cvt_pk_f16_f32 v98, v68, v69
    v_cvt_pk_f16_f32 v99, v70, v71
    ds_write_b64 v31, v[98:99] offset:3696
    v_pk_mul_f32 v[60:61], v[56:57], v[56:57]
    v_pk_mul_f32 v[62:63], v[58:59], v[56:57]
    v_pk_fma_f32 v[60:61], v[58:59], v[58:59], v[60:61] neg_lo:[1,0,0] neg_hi:[1,0,0]
    v_pk_fma_f32 v[62:63], v[56:57], v[58:59], v[62:63]
    v_cvt_pk_f16_f32 v96, v64, v65
    v_cvt_pk_f16_f32 v97, v66, v67
    ds_write_b64 v31, v[96:97] offset:4224
    v_pk_mul_f32 v[68:69], v[64:65], v[52:53]
    v_pk_mul_f32 v[70:71], v[66:67], v[52:53]
    v_pk_fma_f32 v[68:69], v[66:67], v[54:55], v[68:69] neg_lo:[1,0,0] neg_hi:[1,0,0]
    v_pk_fma_f32 v[70:71], v[64:65], v[54:55], v[70:71]
    v_cvt_pk_f16_f32 v98, v68, v69
    v_cvt_pk_f16_f32 v99, v70, v71
    ds_write_b64 v31, v[98:99] offset:4752
    v_pk_mul_f32 v[72:73], v[68:69], v[52:53]
    v_pk_mul_f32 v[74:75], v[70:71], v[52:53]
    v_pk_fma_f32 v[72:73], v[70:71], v[54:55], v[72:73] neg_lo:[1,0,0] neg_hi:[1,0,0]
    v_pk_fma_f32 v[74:75], v[68:69], v[54:55], v[74:75]
    v_cvt_pk_f16_f32 v96, v72, v73
    v_cvt_pk_f16_f32 v97, v74, v75
    ds_write_b64 v31, v[96:97] offset:5280
    buffer_load_dwordx2 v[114:115], v130, s[48:51], 0 offen offset:1024
    v_pk_mul_f32 v[68:69], v[72:73], v[52:53]
    v_pk_mul_f32 v[70:71], v[74:75], v[52:53]
    v_pk_fma_f32 v[68:69], v[74:75], v[54:55], v[68:69] neg_lo:[1,0,0] neg_hi:[1,0,0]
    v_pk_fma_f32 v[70:71], v[72:73], v[54:55], v[70:71]
    v_cvt_pk_f16_f32 v98, v68, v69
    v_cvt_pk_f16_f32 v99, v70, v71
    ds_write_b64 v31, v[98:99] offset:5808
    v_pk_mul_f32 v[72:73], v[68:69], v[52:53]
    v_pk_mul_f32 v[74:75], v[70:71], v[52:53]
    v_pk_fma_f32 v[72:73], v[70:71], v[54:55], v[72:73] neg_lo:[1,0,0] neg_hi:[1,0,0]
    v_pk_fma_f32 v[74:75], v[68:69], v[54:55], v[74:75]
    v_cvt_pk_f16_f32 v96, v72, v73
    v_cvt_pk_f16_f32 v97, v74, v75
    ds_write_b64 v31, v[96:97] offset:6336
    v_pk_mul_f32 v[76:77], v[64:65], v[64:65]
    v_pk_mul_f32 v[78:79], v[66:67], v[64:65]
    v_pk_fma_f32 v[76:77], v[66:67], v[66:67], v[76:77] neg_lo:[1,0,0] neg_hi:[1,0,0]
    v_pk_fma_f32 v[78:79], v[64:65], v[66:67], v[78:79]
    v_cvt_pk_f16_f32 v98, v76, v77
    v_cvt_pk_f16_f32 v99, v78, v79
    ds_write_b64 v31, v[98:99] offset:6864
    v_pk_mul_f32 v[68:69], v[76:77], v[56:57]
    v_pk_mul_f32 v[70:71], v[78:79], v[56:57]
    v_pk_fma_f32 v[68:69], v[78:79], v[58:59], v[68:69] neg_lo:[1,0,0] neg_hi:[1,0,0]
    v_pk_fma_f32 v[70:71], v[76:77], v[58:59], v[70:71]
    v_cvt_pk_f16_f32 v96, v68, v69
    v_cvt_pk_f16_f32 v97, v70, v71
    ds_write_b64 v31, v[96:97] offset:7392
    v_pk_mul_f32 v[72:73], v[68:69], v[56:57]
    v_pk_mul_f32 v[74:75], v[70:71], v[56:57]
    v_pk_fma_f32 v[72:73], v[70:71], v[58:59], v[72:73] neg_lo:[1,0,0] neg_hi:[1,0,0]
    v_pk_fma_f32 v[74:75], v[68:69], v[58:59], v[74:75]
    v_cvt_pk_f16_f32 v98, v72, v73
    v_cvt_pk_f16_f32 v99, v74, v75
    ds_write_b64 v31, v[98:99] offset:7920
    v_pk_mul_f32 v[68:69], v[76:77], v[64:65]
    v_pk_mul_f32 v[70:71], v[78:79], v[64:65]
    v_pk_fma_f32 v[68:69], v[78:79], v[66:67], v[68:69] neg_lo:[1,0,0] neg_hi:[1,0,0]
    v_pk_fma_f32 v[70:71], v[76:77], v[66:67], v[70:71]
    v_cvt_pk_f16_f32 v96, v68, v69
    v_cvt_pk_f16_f32 v97, v70, v71
    ds_write_b64 v31, v[96:97] offset:8448
    buffer_load_dwordx2 v[116:117], v130, s[48:51], 0 offen offset:2048
    v_pk_mul_f32 v[72:73], v[68:69], v[56:57]
    v_pk_mul_f32 v[74:75], v[70:71], v[56:57]
    v_pk_fma_f32 v[72:73], v[70:71], v[58:59], v[72:73] neg_lo:[1,0,0] neg_hi:[1,0,0]
    v_pk_fma_f32 v[74:75], v[68:69], v[58:59], v[74:75]
    v_cvt_pk_f16_f32 v98, v72, v73
    v_cvt_pk_f16_f32 v99, v74, v75
    ds_write_b64 v31, v[98:99] offset:8976
    v_pk_mul_f32 v[76:77], v[72:73], v[56:57]
    v_pk_mul_f32 v[78:79], v[74:75], v[56:57]
    v_pk_fma_f32 v[76:77], v[74:75], v[58:59], v[76:77] neg_lo:[1,0,0] neg_hi:[1,0,0]
    v_pk_fma_f32 v[78:79], v[72:73], v[58:59], v[78:79]
    v_cvt_pk_f16_f32 v96, v76, v77
    v_cvt_pk_f16_f32 v97, v78, v79
    ds_write_b64 v31, v[96:97] offset:9504
    v_pk_mul_f32 v[76:77], v[68:69], v[64:65]
    v_pk_mul_f32 v[78:79], v[70:71], v[64:65]
    v_pk_fma_f32 v[76:77], v[70:71], v[66:67], v[76:77] neg_lo:[1,0,0] neg_hi:[1,0,0]
    v_pk_fma_f32 v[78:79], v[68:69], v[66:67], v[78:79]
    v_cvt_pk_f16_f32 v98, v76, v77
    v_cvt_pk_f16_f32 v99, v78, v79
    ds_write_b64 v31, v[98:99] offset:10032
    v_pk_mul_f32 v[72:73], v[76:77], v[60:61]
    v_pk_mul_f32 v[74:75], v[78:79], v[60:61]
    v_pk_fma_f32 v[72:73], v[78:79], v[62:63], v[72:73] neg_lo:[1,0,0] neg_hi:[1,0,0]
    v_pk_fma_f32 v[74:75], v[76:77], v[62:63], v[74:75]
    v_cvt_pk_f16_f32 v96, v72, v73
    v_cvt_pk_f16_f32 v97, v74, v75
    ds_write_b64 v31, v[96:97] offset:10560
    v_pk_mul_f32 v[68:69], v[76:77], v[64:65]
    v_pk_mul_f32 v[70:71], v[78:79], v[64:65]
    v_pk_fma_f32 v[68:69], v[78:79], v[66:67], v[68:69] neg_lo:[1,0,0] neg_hi:[1,0,0]
    v_pk_fma_f32 v[70:71], v[76:77], v[66:67], v[70:71]
    v_cvt_pk_f16_f32 v98, v68, v69
    v_cvt_pk_f16_f32 v99, v70, v71
    ds_write_b64 v31, v[98:99] offset:11088
    v_pk_mul_f32 v[72:73], v[68:69], v[60:61]
    v_pk_mul_f32 v[74:75], v[70:71], v[60:61]
    v_pk_fma_f32 v[72:73], v[70:71], v[62:63], v[72:73] neg_lo:[1,0,0] neg_hi:[1,0,0]
    v_pk_fma_f32 v[74:75], v[68:69], v[62:63], v[74:75]
    v_cvt_pk_f16_f32 v96, v72, v73
    v_cvt_pk_f16_f32 v97, v74, v75
    ds_write_b64 v31, v[96:97] offset:11616
    buffer_load_dwordx2 v[118:119], v130, s[48:51], 0 offen offset:3072
    v_pk_mul_f32 v[76:77], v[68:69], v[64:65]
    v_pk_mul_f32 v[78:79], v[70:71], v[64:65]
    v_pk_fma_f32 v[76:77], v[70:71], v[66:67], v[76:77] neg_lo:[1,0,0] neg_hi:[1,0,0]
    v_pk_fma_f32 v[78:79], v[68:69], v[66:67], v[78:79]
    v_cvt_pk_f16_f32 v98, v76, v77
    v_cvt_pk_f16_f32 v99, v78, v79
    ds_write_b64 v31, v[98:99] offset:12144
    v_pk_mul_f32 v[72:73], v[76:77], v[60:61]
    v_pk_mul_f32 v[74:75], v[78:79], v[60:61]
    v_pk_fma_f32 v[72:73], v[78:79], v[62:63], v[72:73] neg_lo:[1,0,0] neg_hi:[1,0,0]
    v_pk_fma_f32 v[74:75], v[76:77], v[62:63], v[74:75]
    v_cvt_pk_f16_f32 v96, v72, v73
    v_cvt_pk_f16_f32 v97, v74, v75
    ds_write_b64 v31, v[96:97] offset:12672
    v_pk_mul_f32 v[68:69], v[76:77], v[64:65]
    v_pk_mul_f32 v[70:71], v[78:79], v[64:65]
    v_pk_fma_f32 v[68:69], v[78:79], v[66:67], v[68:69] neg_lo:[1,0,0] neg_hi:[1,0,0]
    v_pk_fma_f32 v[70:71], v[76:77], v[66:67], v[70:71]
    v_cvt_pk_f16_f32 v98, v68, v69
    v_cvt_pk_f16_f32 v99, v70, v71
    ds_write_b64 v31, v[98:99] offset:13200
    v_pk_mul_f32 v[72:73], v[68:69], v[60:61]
    v_pk_mul_f32 v[74:75], v[70:71], v[60:61]
    v_pk_fma_f32 v[72:73], v[70:71], v[62:63], v[72:73] neg_lo:[1,0,0] neg_hi:[1,0,0]
    v_pk_fma_f32 v[74:75], v[68:69], v[62:63], v[74:75]
    v_cvt_pk_f16_f32 v96, v72, v73
    v_cvt_pk_f16_f32 v97, v74, v75
    ds_write_b64 v31, v[96:97] offset:13728
    s_waitcnt lgkmcnt(0)
    s_setprio 0
    s_barrier
    buffer_load_dwordx2 v[120:121], v132, s[48:51], 0 offen
    buffer_load_dwordx2 v[122:123], v130, s[48:51], s14 offen offset:0
    s_waitcnt vmcnt(2)
    s_setprio 2
    s_nop 0
    v_mov_b32_dpp v110, v118 wave_shr:1 row_mask:0xf bank_mask:0xf
    v_mov_b32_dpp v111, v119 wave_shr:1 row_mask:0xf bank_mask:0xf
    v_perm_b32 v68, v116, v118, s68
    v_perm_b32 v69, v112, v114, s68
    v_perm_b32 v70, v114, v116, s68
    v_perm_b32 v71, v110, v112, s68
    v_perm_b32 v72, v116, v118, s69
    v_perm_b32 v73, v112, v114, s69
    v_perm_b32 v74, v114, v116, s69
    v_perm_b32 v75, v110, v112, s69
    v_perm_b32 v76, v117, v119, s68
    v_perm_b32 v77, v113, v115, s68
    v_perm_b32 v78, v115, v117, s68
    v_perm_b32 v79, v111, v113, s68
    v_perm_b32 v80, v117, v119, s69
    v_perm_b32 v81, v113, v115, s69
    v_perm_b32 v82, v115, v117, s69
    v_perm_b32 v83, v111, v113, s69
    ds_write_b64 v133, v[68:69] offset:6624
    ds_write_b64 v133, v[70:71] offset:2048
    ds_write_b64 v133, v[72:73] offset:15776
    ds_write_b64 v133, v[74:75] offset:11200
    ds_write_b64 v133, v[76:77] offset:24928
    ds_write_b64 v133, v[78:79] offset:20352
    ds_write_b64 v133, v[80:81] offset:34080
    ds_write_b64 v133, v[82:83] offset:29504
    s_waitcnt lgkmcnt(0)
    s_barrier
    buffer_load_dwordx2 v[124:125], v130, s[48:51], s14 offen offset:1024
    buffer_load_dwordx2 v[126:127], v130, s[48:51], s14 offen offset:2048
    buffer_load_dwordx2 v[128:129], v130, s[48:51], s14 offen offset:3072
    buffer_load_dwordx2 v[18:19], off, s[60:63], 0 sc1
    s_mov_b32 s52, s20
    s_mov_b32 s53, s21
    s_mov_b32 s54, 524288
    s_mov_b32 s55, 0x20000
    v_lshrrev_b32 v22, 3, v0
    v_and_b32 v23, 7, v0
    v_bfe_u32 v24, v0, 4, 1
    v_lshlrev_b32 v24, 2, v24
    v_xor_b32 v24, v24, v23
    v_lshlrev_b32_e64 v22, 10, v22
    v_lshl_add_u32 v22, v24, 4, v22
    s_lshl_b32 s64, s10, 13
    s_lshr_b32 s65, s2, 5
    s_lshl_b32 s65, s65, 7
    s_add_u32 s64, s64, s65
    v_add_u32_e64 v22, s64, v22
    s_lshl_b32 s64, s10, 10
    s_add_u32 s64, s64, s0
    s_add_u32 m0, s64, 0
    s_mov_b32 s65, 0
    buffer_load_dwordx4 v22, s[52:55], s65 offen lds
    s_add_u32 m0, s64, 4096
    s_mov_b32 s65, 32768
    buffer_load_dwordx4 v22, s[52:55], s65 offen lds
    s_add_u32 m0, s64, 8192
    s_mov_b32 s65, 65536
    buffer_load_dwordx4 v22, s[52:55], s65 offen lds
    s_add_u32 m0, s64, 12288
    s_mov_b32 s65, 98304
    buffer_load_dwordx4 v22, s[52:55], s65 offen lds
    s_waitcnt vmcnt(4)
    s_nop 0
    v_mov_b32_dpp v120, v128 wave_shr:1 row_mask:0xf bank_mask:0xf
    v_mov_b32_dpp v121, v129 wave_shr:1 row_mask:0xf bank_mask:0xf
    v_perm_b32 v68, v126, v128, s68
    v_perm_b32 v69, v122, v124, s68
    v_perm_b32 v70, v124, v126, s68
    v_perm_b32 v71, v120, v122, s68
    v_perm_b32 v72, v126, v128, s69
    v_perm_b32 v73, v122, v124, s69
    v_perm_b32 v74, v124, v126, s69
    v_perm_b32 v75, v120, v122, s69
    v_perm_b32 v76, v127, v129, s68
    v_perm_b32 v77, v123, v125, s68
    v_perm_b32 v78, v125, v127, s68
    v_perm_b32 v79, v121, v123, s68
    v_perm_b32 v80, v127, v129, s69
    v_perm_b32 v81, v123, v125, s69
    v_perm_b32 v82, v125, v127, s69
    v_perm_b32 v83, v121, v123, s69
    ds_write_b64 v133, v[68:69] offset:4576
    ds_write_b64 v133, v[70:71] offset:0
    ds_write_b64 v133, v[72:73] offset:13728
    ds_write_b64 v133, v[74:75] offset:9152
    ds_write_b64 v133, v[76:77] offset:22880
    ds_write_b64 v133, v[78:79] offset:18304
    ds_write_b64 v133, v[80:81] offset:32032
    ds_write_b64 v133, v[82:83] offset:27456
    v_cmp_eq_u32_e64 vcc, 0, v19
    s_nop 1
    s_cbranch_vccz L_c_non_done
    s_mov_b32 s72, 65536
L_c_non:
    buffer_load_dwordx2 v[18:19], off, s[60:63], 0 sc1
    s_sub_u32 s72, s72, 1
    s_waitcnt vmcnt(0)
    v_cmp_eq_u32 vcc, 0, v19
    s_cmp_eq_u32 s72, 0
    s_cbranch_scc1 L_c_non_done
    s_cbranch_vccz L_c_non_done
    s_sleep 4
    s_branch L_c_non
L_c_non_done:
    v_mov_b32 v16, 0
    v_mov_b32 v17, 0
    v_mov_b32 v15, 161536
    ds_write_b128 v15, v[16:19]
    ds_write_b32 v15, v16 offset:16
    s_add_u32 s64, s64, s1
    s_add_u32 m0, s64, 0
    s_mov_b32 s65, 131072
    buffer_load_dwordx4 v22, s[52:55], s65 offen lds
    s_add_u32 m0, s64, 4096
    s_mov_b32 s65, 163840
    buffer_load_dwordx4 v22, s[52:55], s65 offen lds
    s_add_u32 m0, s64, 8192
    s_mov_b32 s65, 196608
    buffer_load_dwordx4 v22, s[52:55], s65 offen lds
    s_add_u32 m0, s64, 12288
    s_mov_b32 s65, 229376
    buffer_load_dwordx4 v22, s[52:55], s65 offen lds
    s_add_u32 s64, s64, s1
    s_add_u32 m0, s64, 0
    s_mov_b32 s65, 262144
    buffer_load_dwordx4 v22, s[52:55], s65 offen lds
    s_add_u32 m0, s64, 4096
    s_mov_b32 s65, 294912
    buffer_load_dwordx4 v22, s[52:55], s65 offen lds
    s_add_u32 m0, s64, 8192
    s_mov_b32 s65, 327680
    buffer_load_dwordx4 v22, s[52:55], s65 offen lds
    s_add_u32 m0, s64, 12288
    s_mov_b32 s65, 360448
    buffer_load_dwordx4 v22, s[52:55], s65 offen lds
    s_add_u32 s64, s64, s1
    s_add_u32 m0, s64, 0
    s_mov_b32 s65, 393216
    buffer_load_dwordx4 v22, s[52:55], s65 offen lds
    s_add_u32 m0, s64, 4096
    s_mov_b32 s65, 425984
    buffer_load_dwordx4 v22, s[52:55], s65 offen lds
    s_add_u32 m0, s64, 8192
    s_mov_b32 s65, 458752
    buffer_load_dwordx4 v22, s[52:55], s65 offen lds
    s_add_u32 m0, s64, 12288
    s_mov_b32 s65, 491520
    buffer_load_dwordx4 v22, s[52:55], s65 offen lds
    s_waitcnt vmcnt(0) lgkmcnt(0)
    s_barrier
    s_and_b32 s7, s6, 3
    s_lshl_b32 s8, s4, 2
    s_add_u32 s7, s7, s8
    s_lshr_b32 s8, s6, 2
    v_lshrrev_b32 v76, 3, v0
    v_and_b32 v77, 7, v0
    v_lshlrev_b32_e64 v70, 12, v76
    v_lshl_add_u32 v70, v77, 4, v70
    s_lshl_b32 s13, s8, 18
    s_lshl_b32 s12, s10, 15
    s_add_u32 s13, s13, s12
    s_lshl_b32 s12, s7, 7
    s_add_u32 s13, s13, s12
    s_add_u32 s13, s13, 2097152
    s_add_u32 s14, s13, 131072
    s_lshl_b32 s12, s10, 10
    s_add_u32 s15, s12, s23
    v_lshl_add_u32 v71, v0, 4, s15
    s_lshr_b32 s64, s7, 3
    s_lshl_b32 s64, s64, 2
    s_bfe_u32 s65, s7, 0x10002
    s_add_u32 s64, s64, s65
    s_lshl_b32 s64, s64, 10
    s_add_u32 s11, s64, 4292608
    v_and_b32 v76, 8, v0
    v_lshl_add_u32 v81, v76, 1, v77
    v_lshlrev_b32 v81, 7, v81
    v_and_b32 v76, 1, v0
    v_and_b32_e64 v77, 2, v0
    v_lshl_add_u32 v82, v77, 2, v76
    v_lshlrev_b32 v82, 7, v82
    s_lshl_b32 s67, s8, 11
    s_lshl_b32 s65, s10, 8
    s_add_u32 s67, s67, s65
    s_add_u32 s67, s67, 4308992
    v_mov_b32 v83, s75
    s_mul_i32 s64, s10, s73
    s_add_u32 s64, s64, s22
    v_lshrrev_b32 v76, 5, v0
    v_mul_u32_u24 v76, 544, v76
    v_bfe_u32 v77, v0, 3, 2
    v_and_b32 v78, 7, v0
    v_min_u32 v78, 5, v78
    v_mul_u32_u24_e64 v79, 12, v78
    v_lshl_add_u32 v79, v77, 6, v79
    v_add3_u32 v72, v76, v79, s64
    v_and_b32_e64 v79, 1, v77
    v_mul_u32_u24 v79, 272, v79
    v_lshrrev_b32_e64 v77, 1, v77
    v_lshl_add_u32 v79, v77, 3, v79
    v_add3_u32 v79, v76, v79, s64
    v_add_u32 v79, 252, v79
    v_cmp_eq_u32_e64 vcc, 5, v78
    v_add_u32 v80, -272, v79
    v_lshlrev_b32 v78, 4, v78
    v_cndmask_b32 v73, v72, v79, vcc
    v_cndmask_b32 v74, v72, v80, vcc
    v_lshrrev_b32 v76, 3, v0
    v_lshl_add_u32 v75, v76, 7, v78
    s_lshl_b32 s68, s10, 13
    s_add_u32 s68, s68, 4194304
    s_add_u32 s69, s68, 4096
    s_sleep 40
L_p2help:
    s_cmp_lg_u32 s3, 7
    s_cbranch_scc1 L_hwait
    s_mov_b32 s72, 65536
L_fl:
    buffer_load_dwordx2 v[8:9], v81, s[56:59], s11 offen sc1
    s_sub_u32 s72, s72, 1
    s_waitcnt vmcnt(0)
    v_cmp_ne_u64 vcc, v[8:9], v[18:19]
    s_cmp_eq_u32 s72, 0
    s_cbranch_scc1 L_fl_done
    s_cbranch_vccz L_fl_done
    s_sleep 1
    s_branch L_fl
L_fl_done:
    ds_write_b32 v83, v19 offset:4
    s_branch L_hgo_done
L_hwait:
    s_mov_b32 s72, 262144
L_hgo:
    ds_read_b32 v8, v83 offset:4
    s_sub_u32 s72, s72, 1
    s_waitcnt lgkmcnt(0)
    v_readfirstlane_b32 s64, v8
    s_nop 0
    s_cmp_lg_u32 s64, 0
    s_cbranch_scc1 L_hgo_done
    s_sleep 1
    s_cmp_lg_u32 s72, 0
    s_cbranch_scc1 L_hgo
L_hgo_done:
    buffer_load_dwordx4 v[84:87], v75, s[56:59], s68 offen offset:0 sc1
    buffer_load_dwordx4 v[88:91], v75, s[56:59], s68 offen offset:1024 sc1
    buffer_load_dwordx4 v[92:95], v75, s[56:59], s68 offen offset:2048 sc1
    buffer_load_dwordx4 v[96:99], v75, s[56:59], s68 offen offset:3072 sc1
    buffer_load_dwordx4 v[100:103], v75, s[56:59], s69 offen offset:0 sc1
    buffer_load_dwordx4 v[104:107], v75, s[56:59], s69 offen offset:1024 sc1
    buffer_load_dwordx4 v[108:111], v75, s[56:59], s69 offen offset:2048 sc1
    buffer_load_dwordx4 v[112:115], v75, s[56:59], s69 offen offset:3072 sc1
    s_mov_b32 s72, 65536
L_kvf:
    s_waitcnt vmcnt(0)
    v_xor_b32 v116, v87, v18
    v_xor_b32 v117, v91, v18
    v_xor_b32 v118, v95, v18
    v_xor_b32 v119, v99, v18
    v_xor_b32 v120, v103, v18
    v_xor_b32 v121, v107, v18
    v_xor_b32 v122, v111, v18
    v_xor_b32_e64 v123, v115, v18
    v_or3_b32 v124, v116, v117, v118
    v_or3_b32 v125, v119, v120, v121
    v_or3_b32 v124, v124, v122, v123
    v_or_b32 v124, v124, v125
    v_cmp_ne_u32 vcc, 0, v124
    s_sub_u32 s72, s72, 1
    s_cbranch_vccz L_kvf_done
    s_sleep 4
    v_cmp_ne_u32_e64 vcc, 0, v116
    s_nop 0
    s_or_b32 exec_lo, vcc_lo, 1
    s_mov_b32 exec_hi, vcc_hi
    buffer_load_dwordx4 v[84:87], v75, s[56:59], s68 offen offset:0 sc1
    s_mov_b64 exec, -1
    v_cmp_ne_u32_e64 vcc, 0, v117
    s_nop 0
    s_or_b32 exec_lo, vcc_lo, 1
    s_mov_b32 exec_hi, vcc_hi
    buffer_load_dwordx4 v[88:91], v75, s[56:59], s68 offen offset:1024 sc1
    s_mov_b64 exec, -1
    v_cmp_ne_u32_e64 vcc, 0, v118
    s_nop 0
    s_or_b32 exec_lo, vcc_lo, 1
    s_mov_b32 exec_hi, vcc_hi
    buffer_load_dwordx4 v[92:95], v75, s[56:59], s68 offen offset:2048 sc1
    s_mov_b64 exec, -1
    v_cmp_ne_u32_e64 vcc, 0, v119
    s_nop 0
    s_or_b32 exec_lo, vcc_lo, 1
    s_mov_b32 exec_hi, vcc_hi
    buffer_load_dwordx4 v[96:99], v75, s[56:59], s68 offen offset:3072 sc1
    s_mov_b64 exec, -1
    v_cmp_ne_u32_e64 vcc, 0, v120
    s_nop 0
    s_or_b32 exec_lo, vcc_lo, 1
    s_mov_b32 exec_hi, vcc_hi
    buffer_load_dwordx4 v[100:103], v75, s[56:59], s69 offen offset:0 sc1
    s_mov_b64 exec, -1
    v_cmp_ne_u32_e64 vcc, 0, v121
    s_nop 0
    s_or_b32 exec_lo, vcc_lo, 1
    s_mov_b32 exec_hi, vcc_hi
    buffer_load_dwordx4 v[104:107], v75, s[56:59], s69 offen offset:1024 sc1
    s_mov_b64 exec, -1
    v_cmp_ne_u32_e64 vcc, 0, v122
    s_nop 0
    s_or_b32 exec_lo, vcc_lo, 1
    s_mov_b32 exec_hi, vcc_hi
    buffer_load_dwordx4 v[108:111], v75, s[56:59], s69 offen offset:2048 sc1
    s_mov_b64 exec, -1
    v_cmp_ne_u32_e64 vcc, 0, v123
    s_nop 0
    s_or_b32 exec_lo, vcc_lo, 1
    s_mov_b32 exec_hi, vcc_hi
    buffer_load_dwordx4 v[112:115], v75, s[56:59], s69 offen offset:3072 sc1
    s_mov_b64 exec, -1
    s_cmp_lg_u32 s72, 0
    s_cbranch_scc1 L_kvf
L_kvf_done:
    s_waitcnt vmcnt(0)
    ds_write_b32 v72, v84 offset:0
    ds_write_b32 v73, v85 offset:4
    ds_write_b32 v73, v86 offset:8
    ds_write_b32 v72, v88 offset:272
    ds_write_b32 v74, v89 offset:276
    ds_write_b32 v74, v90 offset:280
    ds_write_b32 v72, v92 offset:1088
    ds_write_b32 v73, v93 offset:1092
    ds_write_b32 v73, v94 offset:1096
    ds_write_b32 v72, v96 offset:1360
    ds_write_b32 v74, v97 offset:1364
    ds_write_b32 v74, v98 offset:1368
    ds_write_b32 v72, v100 offset:2176
    ds_write_b32 v73, v101 offset:2180
    ds_write_b32 v73, v102 offset:2184
    ds_write_b32 v72, v104 offset:2448
    ds_write_b32 v74, v105 offset:2452
    ds_write_b32 v74, v106 offset:2456
    ds_write_b32 v72, v108 offset:3264
    ds_write_b32 v73, v109 offset:3268
    ds_write_b32 v73, v110 offset:3272
    ds_write_b32 v72, v112 offset:3536
    ds_write_b32 v74, v113 offset:3540
    ds_write_b32 v74, v114 offset:3544
    s_waitcnt lgkmcnt(0)
    s_barrier
    s_mov_b32 s72, 65536
L_fb:
    buffer_load_dwordx2 v[8:9], v82, s[56:59], s67 offen sc1
    s_sub_u32 s72, s72, 1
    s_waitcnt vmcnt(0)
    v_cmp_ne_u64 vcc, v[8:9], v[18:19]
    s_cmp_eq_u32 s72, 0
    s_cbranch_scc1 L_fb_done
    s_cbranch_vccz L_fb_done
    s_sleep 1
    s_branch L_fb
L_fb_done:
    buffer_load_dwordx4 v[44:47], v70, s[56:59], s13 offen sc1
    buffer_load_dwordx4 v[48:51], v70, s[56:59], s14 offen sc1
    s_waitcnt vmcnt(0)
    ds_write_b128 v71, v[44:47]
    ds_write_b128 v71, v[48:51] offset:4096
    s_waitcnt lgkmcnt(0)
    s_barrier
    s_endpgm
.p2align 3
L_p2comp:
    s_and_b32 s7, s6, 3
    s_lshl_b32 s8, s4, 2
    s_add_u32 s7, s7, s8
    s_lshr_b32 s8, s6, 2
    s_and_b32 s10, s3, 1
    s_lshr_b32 s11, s3, 1
    s_lshr_b32 s9, s7, 3
    s_lshl_b32 s9, s9, 4
    s_and_b32 s12, s7, 7
    s_add_u32 s9, s9, s12
    s_lshl_b32 s12, s10, 3
    s_add_u32 s9, s9, s12
    v_lshrrev_b32_e64 v100, 5, v0
    v_bfe_u32 v101, v0, 2, 2
    v_lshl_add_u32 v101, v100, 2, v101
    v_lshlrev_b32 v101, 7, v101
    v_and_b32 v102, 3, v0
    v_bfe_u32 v103, v0, 4, 1
    v_lshlrev_b32_e64 v104, 3, v102
    v_lshl_add_u32 v104, v103, 5, v104
    v_bfe_u32 v105, v0, 3, 1
    v_xor_b32_e64 v105, s11, v105
    v_lshl_add_u32 v104, v105, 6, v104
    s_lshl_b32 s66, s11, 12
    s_add_u32 s67, s66, s0
    v_add3_u32 v106, v101, v104, s67
    v_xor_b32 v107, 64, v106
    v_mov_b32 v14, v106
    v_mov_b32 v15, v107
    v_lshlrev_b32 v110, 1, v102
    v_bfe_u32 v111, v0, 2, 1
    v_add_u32 v110, v110, v111
    v_and_b32 v111, 24, v0
    v_add_u32_e64 v110, v110, v111
    v_lshl_add_u32 v3, v100, 5, v110
    v_lshlrev_b32_e64 v3, 4, v3
    s_lshl_b32 s12, s9, 15
    s_lshl_b32 s13, s11, 11
    s_add_u32 s12, s12, s13
    s_lshl_b32 s13, s9, 7
    s_add_u32 s13, s13, 4259840
    v_lshlrev_b32 v12, 2, v110
    v_and_b32 v108, 31, v0
    v_min_u32_e64 v108, 16, v108
    v_mul_u32_u24 v109, 272, v100
    v_lshl_add_u32 v108, v108, 4, v109
    s_mul_i32 s65, s11, 1088
    s_add_u32 s65, s65, s22
    v_add_u32 v4, s65, v108
    v_lshlrev_b32_e64 v104, 4, v102
    v_lshl_add_u32 v104, v103, 6, v104
    s_lshl_b32 s67, s10, 3
    s_add_u32 s66, s66, s67
    s_add_u32 s66, s66, s23
    v_add3_u32 v7, v101, v104, s66
    v_lshlrev_b32 v108, 10, v110
    v_lshl_add_u32 v8, v100, 4, v108
    s_lshl_b32 s14, s9, 15
    s_lshl_b32 s66, s8, 7
    s_add_u32 s14, s14, s66
    s_lshl_b32 s66, s11, 6
    s_add_u32 s14, s14, s66
    s_mul_i32 s66, s3, s1
    s_add_u32 s66, s66, s0
    v_lshl_add_u32 v9, v0, 4, s66
    s_xor_b32 s66, s3, 2
    s_mul_i32 s66, s66, s1
    s_add_u32 s66, s66, s0
    v_lshl_add_u32 v10, v0, 4, s66
    s_mov_b32 s71, 897988541
    s_mov_b32 s60, s42
    s_mov_b32 s61, s43
    s_mov_b32 s62, 2097152
    s_mov_b32 s63, 0x20000
    v_mov_b32 v113, s75
    s_cmp_lg_u32 s24, 0
    s_cbranch_scc1 L_carr
    s_waitcnt vmcnt(0)
    s_barrier
    s_branch L_carr_e
L_carr:
    v_mov_b32_e64 v112, 1
    ds_read_b64 v[114:115], v113 offset:8
    s_mov_b64 exec, 1
    s_waitcnt vmcnt(0)
    ds_add_rtn_u32 v112, v113, v112
    s_waitcnt lgkmcnt(0)
    v_readfirstlane_b32 s64, v112
    s_nop 0
    s_cmp_lg_u32 s64, 3
    s_cbranch_scc1 L_carr_nl
    buffer_store_dwordx2 v[114:115], off, s[56:59], s74 sc1
L_carr_nl:
    s_mov_b64 exec, -1
L_carr_e:
    ds_read_b64_tr_b16 v[160:161], v14 offset:0
    ds_read_b64_tr_b16 v[162:163], v14 offset:1024
    ds_read_b64_tr_b16 v[164:165], v15 offset:0
    ds_read_b64_tr_b16 v[166:167], v15 offset:1024
    ds_read_b64_tr_b16 v[168:169], v14 offset:2048
    ds_read_b64_tr_b16 v[170:171], v14 offset:3072
    ds_read_b64_tr_b16 v[172:173], v15 offset:2048
    ds_read_b64_tr_b16 v[174:175], v15 offset:3072
    ds_read_b64_tr_b16 v[176:177], v14 offset:8192
    ds_read_b64_tr_b16 v[178:179], v14 offset:9216
    ds_read_b64_tr_b16 v[180:181], v15 offset:8192
    ds_read_b64_tr_b16 v[182:183], v15 offset:9216
    ds_read_b64_tr_b16 v[184:185], v14 offset:10240
    ds_read_b64_tr_b16 v[186:187], v14 offset:11264
    ds_read_b64_tr_b16 v[188:189], v15 offset:10240
    ds_read_b64_tr_b16 v[190:191], v15 offset:11264
    v_add_u32 v14, s1, v14
    v_add_u32 v15, s1, v15
    ds_read_b64_tr_b16 v[192:193], v14 offset:0
    ds_read_b64_tr_b16 v[194:195], v14 offset:1024
    ds_read_b64_tr_b16 v[196:197], v15 offset:0
    ds_read_b64_tr_b16 v[198:199], v15 offset:1024
    ds_read_b64_tr_b16 v[200:201], v14 offset:2048
    ds_read_b64_tr_b16 v[202:203], v14 offset:3072
    ds_read_b64_tr_b16 v[204:205], v15 offset:2048
    ds_read_b64_tr_b16 v[206:207], v15 offset:3072
    ds_read_b64_tr_b16 v[208:209], v14 offset:8192
    ds_read_b64_tr_b16 v[210:211], v14 offset:9216
    ds_read_b64_tr_b16 v[212:213], v15 offset:8192
    ds_read_b64_tr_b16 v[214:215], v15 offset:9216
    ds_read_b64_tr_b16 v[216:217], v14 offset:10240
    ds_read_b64_tr_b16 v[218:219], v14 offset:11264
    ds_read_b64_tr_b16 v[220:221], v15 offset:10240
    ds_read_b64_tr_b16 v[222:223], v15 offset:11264
    v_add_u32 v14, s1, v14
    v_add_u32 v15, s1, v15
    ds_read_b64_tr_b16 v[224:225], v14 offset:0
    ds_read_b64_tr_b16 v[226:227], v14 offset:1024
    ds_read_b64_tr_b16 v[228:229], v15 offset:0
    ds_read_b64_tr_b16 v[230:231], v15 offset:1024
    ds_read_b64_tr_b16 v[232:233], v14 offset:2048
    ds_read_b64_tr_b16 v[234:235], v14 offset:3072
    ds_read_b64_tr_b16 v[236:237], v15 offset:2048
    ds_read_b64_tr_b16 v[238:239], v15 offset:3072
    ds_read_b64_tr_b16 v[240:241], v14 offset:8192
    ds_read_b64_tr_b16 v[242:243], v14 offset:9216
    ds_read_b64_tr_b16 v[244:245], v15 offset:8192
    ds_read_b64_tr_b16 v[246:247], v15 offset:9216
    ds_read_b64_tr_b16 v[248:249], v14 offset:10240
    ds_read_b64_tr_b16 v[250:251], v14 offset:11264
    ds_read_b64_tr_b16 v[252:253], v15 offset:10240
    ds_read_b64_tr_b16 v[254:255], v15 offset:11264
    v_add_u32 v14, s1, v14
    v_add_u32 v15, s1, v15
    s_mov_b32 s72, 262144
L_cgo:
    ds_read_b32 v112, v113 offset:4
    s_sub_u32 s72, s72, 1
    s_waitcnt lgkmcnt(0)
    v_readfirstlane_b32 s64, v112
    s_nop 0
    s_cmp_lg_u32 s64, 0
    s_cbranch_scc1 L_cgo_done
    s_sleep 1
    s_cmp_lg_u32 s72, 0
    s_cbranch_scc1 L_cgo
L_cgo_done:
    s_sleep 3
    buffer_load_dword v2, v12, s[56:59], s13 offen sc1
    s_add_u32 s15, s12, 0
    s_nop 0
    buffer_load_dwordx4 v[96:99], v3, s[56:59], s15 offen offset:0 sc1
    buffer_load_dwordx4 v[100:103], v3, s[56:59], s15 offen offset:1024 sc1
    s_add_u32 s15, s12, 4096
    buffer_load_dwordx4 v[104:107], v3, s[56:59], s15 offen offset:0 sc1
    buffer_load_dwordx4 v[108:111], v3, s[56:59], s15 offen offset:1024 sc1
    s_add_u32 s15, s12, 8192
    buffer_load_dwordx4 v[112:115], v3, s[56:59], s15 offen offset:0 sc1
    buffer_load_dwordx4 v[116:119], v3, s[56:59], s15 offen offset:1024 sc1
    s_add_u32 s15, s12, 12288
    buffer_load_dwordx4 v[120:123], v3, s[56:59], s15 offen offset:0 sc1
    buffer_load_dwordx4 v[124:127], v3, s[56:59], s15 offen offset:1024 sc1
    s_add_u32 s15, s12, 16384
    buffer_load_dwordx4 v[128:131], v3, s[56:59], s15 offen offset:0 sc1
    buffer_load_dwordx4 v[132:135], v3, s[56:59], s15 offen offset:1024 sc1
    s_barrier
    ds_read_b128 v[88:91], v4 offset:0
    ds_read_b128 v[92:95], v4 offset:544
    s_waitcnt vmcnt(9) lgkmcnt(0)
    v_mfma_f32_32x32x16_bf16 v[48:63], v[88:91], v[96:99], 0
    ds_read_b128 v[88:91], v4 offset:2176
    s_add_u32 s15, s12, 20480
    buffer_load_dwordx4 v[136:139], v3, s[56:59], s15 offen offset:0 sc1
    v_sub_f32 v12, 1.0, v2
    s_waitcnt vmcnt(9) lgkmcnt(1)
    v_mfma_f32_32x32x16_bf16 v[64:79], v[92:95], v[100:103], 0
    ds_read_b128 v[92:95], v4 offset:2720
    buffer_load_dwordx4 v[140:143], v3, s[56:59], s15 offen offset:1024 sc1
    s_nop 3
    v_add_f32 v56, s71, v56
    v_rcp_f32 v56, v56
    s_nop 0
    v_mul_f32 v56, v2, v56
    v_mul_f32 v48, v56, v48
    v_mul_f32_e64 v49, v56, v49
    v_cvt_pk_bf16_f32 v80, v48, v49
    v_mul_f32 v50, v56, v50
    v_mul_f32 v51, v56, v51
    v_cvt_pk_bf16_f32 v81, v50, v51
    v_mul_f32 v52, v56, v52
    v_mul_f32 v53, v56, v53
    v_cvt_pk_bf16_f32 v82, v52, v53
    v_mul_f32 v54, v56, v54
    v_mul_f32 v55, v56, v55
    v_cvt_pk_bf16_f32 v83, v54, v55
    v_add_f32 v72, s71, v72
    v_rcp_f32_e64 v72, v72
    s_waitcnt vmcnt(9) lgkmcnt(1)
    v_mfma_f32_32x32x16_bf16 v[48:63], v[88:91], v[104:107], 0
    v_add_u32_e64 v4, s73, v4
    ds_read_b128 v[88:91], v4 offset:0
    s_add_u32 s15, s12, 24576
    buffer_load_dwordx4 v[144:147], v3, s[56:59], s15 offen offset:0 sc1
    v_mul_f32 v72, v2, v72
    v_mul_f32 v64, v72, v64
    v_mul_f32_e64 v65, v72, v65
    v_cvt_pk_bf16_f32 v84, v64, v65
    v_mfma_f32_32x32x16_bf16 v[32:47], v[164:167], v[80:83], 0
    v_mul_f32 v66, v72, v66
    v_mul_f32 v67, v72, v67
    v_cvt_pk_bf16_f32 v85, v66, v67
    v_mul_f32 v68, v72, v68
    v_mul_f32 v69, v72, v69
    v_mfma_f32_32x32x16_bf16 v[16:31], v[160:163], v[80:83], 0
    v_cvt_pk_bf16_f32 v86, v68, v69
    v_mul_f32 v70, v72, v70
    v_mul_f32 v71, v72, v71
    v_cvt_pk_bf16_f32 v87, v70, v71
    v_add_f32 v56, s71, v56
    v_rcp_f32_e64 v56, v56
    s_waitcnt vmcnt(9) lgkmcnt(1)
    v_mfma_f32_32x32x16_bf16 v[64:79], v[92:95], v[108:111], 0
    ds_read_b128 v[92:95], v4 offset:544
    buffer_load_dwordx4 v[148:151], v3, s[56:59], s15 offen offset:1024 sc1
    v_mul_f32 v56, v2, v56
    v_mul_f32 v48, v56, v48
    v_mul_f32_e64 v49, v56, v49
    v_cvt_pk_bf16_f32 v80, v48, v49
    v_mfma_f32_32x32x16_bf16 v[32:47], v[172:175], v[84:87], v[32:47]
    v_mul_f32 v50, v56, v50
    v_mul_f32 v51, v56, v51
    v_cvt_pk_bf16_f32 v81, v50, v51
    v_mul_f32 v52, v56, v52
    v_mul_f32 v53, v56, v53
    v_mfma_f32_32x32x16_bf16 v[16:31], v[168:171], v[84:87], v[16:31]
    v_cvt_pk_bf16_f32 v82, v52, v53
    v_mul_f32 v54, v56, v54
    v_mul_f32 v55, v56, v55
    v_cvt_pk_bf16_f32 v83, v54, v55
    v_add_f32 v72, s71, v72
    v_rcp_f32_e64 v72, v72
    s_waitcnt vmcnt(9) lgkmcnt(1)
    v_mfma_f32_32x32x16_bf16 v[48:63], v[88:91], v[112:115], 0
    ds_read_b128 v[88:91], v4 offset:2176
    s_add_u32 s15, s12, 28672
    buffer_load_dwordx4 v[152:155], v3, s[56:59], s15 offen offset:0 sc1
    v_mul_f32 v72, v2, v72
    v_mul_f32 v64, v72, v64
    v_mul_f32_e64 v65, v72, v65
    v_cvt_pk_bf16_f32 v84, v64, v65
    v_mfma_f32_32x32x16_bf16 v[32:47], v[180:183], v[80:83], v[32:47]
    v_mul_f32 v66, v72, v66
    v_mul_f32 v67, v72, v67
    v_cvt_pk_bf16_f32 v85, v66, v67
    v_mul_f32 v68, v72, v68
    v_mul_f32 v69, v72, v69
    v_mfma_f32_32x32x16_bf16 v[16:31], v[176:179], v[80:83], v[16:31]
    v_cvt_pk_bf16_f32 v86, v68, v69
    v_mul_f32 v70, v72, v70
    v_mul_f32 v71, v72, v71
    v_cvt_pk_bf16_f32 v87, v70, v71
    v_add_f32 v56, s71, v56
    v_rcp_f32_e64 v56, v56
    s_waitcnt vmcnt(9) lgkmcnt(1)
    v_mfma_f32_32x32x16_bf16 v[64:79], v[92:95], v[116:119], 0
    ds_read_b128 v[92:95], v4 offset:2720
    buffer_load_dwordx4 v[156:159], v3, s[56:59], s15 offen offset:1024 sc1
    v_mul_f32 v56, v2, v56
    v_mul_f32 v48, v56, v48
    v_mul_f32_e64 v49, v56, v49
    v_cvt_pk_bf16_f32 v80, v48, v49
    v_mfma_f32_32x32x16_bf16 v[32:47], v[188:191], v[84:87], v[32:47]
    v_mul_f32 v50, v56, v50
    v_mul_f32 v51, v56, v51
    v_cvt_pk_bf16_f32 v81, v50, v51
    v_mul_f32 v52, v56, v52
    v_mul_f32 v53, v56, v53
    v_mfma_f32_32x32x16_bf16 v[16:31], v[184:187], v[84:87], v[16:31]
    v_cvt_pk_bf16_f32 v82, v52, v53
    v_mul_f32 v54, v56, v54
    v_mul_f32 v55, v56, v55
    v_cvt_pk_bf16_f32 v83, v54, v55
    v_add_f32 v72, s71, v72
    v_rcp_f32_e64 v72, v72
    s_waitcnt vmcnt(9) lgkmcnt(1)
    v_mfma_f32_32x32x16_bf16 v[48:63], v[88:91], v[120:123], 0
    v_add_u32_e64 v4, s73, v4
    ds_read_b128 v[88:91], v4 offset:0
    v_mul_f32 v72, v2, v72
    v_mul_f32 v64, v72, v64
    v_mul_f32_e64 v65, v72, v65
    v_cvt_pk_bf16_f32 v84, v64, v65
    v_mfma_f32_32x32x16_bf16 v[32:47], v[196:199], v[80:83], v[32:47]
    v_mul_f32 v66, v72, v66
    v_mul_f32 v67, v72, v67
    v_cvt_pk_bf16_f32 v85, v66, v67
    v_mul_f32 v68, v72, v68
    v_mul_f32 v69, v72, v69
    v_mfma_f32_32x32x16_bf16 v[16:31], v[192:195], v[80:83], v[16:31]
    v_cvt_pk_bf16_f32 v86, v68, v69
    v_mul_f32 v70, v72, v70
    v_mul_f32 v71, v72, v71
    v_cvt_pk_bf16_f32 v87, v70, v71
    v_add_f32 v56, s71, v56
    v_rcp_f32_e64 v56, v56
    s_waitcnt vmcnt(8) lgkmcnt(1)
    v_mfma_f32_32x32x16_bf16 v[64:79], v[92:95], v[124:127], 0
    ds_read_b128 v[92:95], v4 offset:544
    v_mul_f32 v56, v2, v56
    v_mul_f32 v48, v56, v48
    v_mul_f32_e64 v49, v56, v49
    v_cvt_pk_bf16_f32 v80, v48, v49
    v_mfma_f32_32x32x16_bf16 v[32:47], v[204:207], v[84:87], v[32:47]
    v_mul_f32 v50, v56, v50
    v_mul_f32 v51, v56, v51
    v_cvt_pk_bf16_f32 v81, v50, v51
    v_mul_f32 v52, v56, v52
    v_mul_f32 v53, v56, v53
    v_mfma_f32_32x32x16_bf16 v[16:31], v[200:203], v[84:87], v[16:31]
    v_cvt_pk_bf16_f32 v82, v52, v53
    v_mul_f32 v54, v56, v54
    v_mul_f32 v55, v56, v55
    v_cvt_pk_bf16_f32 v83, v54, v55
    v_add_f32 v72, s71, v72
    v_rcp_f32_e64 v72, v72
    s_waitcnt vmcnt(7) lgkmcnt(1)
    v_mfma_f32_32x32x16_bf16 v[48:63], v[88:91], v[128:131], 0
    ds_read_b128 v[88:91], v4 offset:2176
    v_mul_f32 v72, v2, v72
    v_mul_f32 v64, v72, v64
    v_mul_f32_e64 v65, v72, v65
    v_cvt_pk_bf16_f32 v84, v64, v65
    v_mfma_f32_32x32x16_bf16 v[32:47], v[212:215], v[80:83], v[32:47]
    v_mul_f32 v66, v72, v66
    v_mul_f32 v67, v72, v67
    v_cvt_pk_bf16_f32 v85, v66, v67
    v_mul_f32 v68, v72, v68
    v_mul_f32 v69, v72, v69
    v_mfma_f32_32x32x16_bf16 v[16:31], v[208:211], v[80:83], v[16:31]
    v_cvt_pk_bf16_f32 v86, v68, v69
    v_mul_f32 v70, v72, v70
    v_mul_f32 v71, v72, v71
    v_cvt_pk_bf16_f32 v87, v70, v71
    v_add_f32 v56, s71, v56
    v_rcp_f32_e64 v56, v56
    s_waitcnt vmcnt(6) lgkmcnt(1)
    v_mfma_f32_32x32x16_bf16 v[64:79], v[92:95], v[132:135], 0
    ds_read_b64_tr_b16 v[96:97], v14 offset:0
    ds_read_b64_tr_b16 v[98:99], v14 offset:1024
    ds_read_b64_tr_b16 v[100:101], v15 offset:0
    ds_read_b64_tr_b16 v[102:103], v15 offset:1024
    ds_read_b128 v[92:95], v4 offset:2720
    v_mul_f32 v56, v2, v56
    v_mul_f32 v48, v56, v48
    v_mul_f32_e64 v49, v56, v49
    v_cvt_pk_bf16_f32 v80, v48, v49
    v_mfma_f32_32x32x16_bf16 v[32:47], v[220:223], v[84:87], v[32:47]
    v_mul_f32 v50, v56, v50
    v_mul_f32 v51, v56, v51
    v_cvt_pk_bf16_f32 v81, v50, v51
    v_mul_f32 v52, v56, v52
    v_mul_f32 v53, v56, v53
    v_mfma_f32_32x32x16_bf16 v[16:31], v[216:219], v[84:87], v[16:31]
    v_cvt_pk_bf16_f32 v82, v52, v53
    v_mul_f32 v54, v56, v54
    v_mul_f32 v55, v56, v55
    v_cvt_pk_bf16_f32 v83, v54, v55
    v_add_f32 v72, s71, v72
    v_rcp_f32_e64 v72, v72
    s_waitcnt vmcnt(5) lgkmcnt(1)
    v_mfma_f32_32x32x16_bf16 v[48:63], v[88:91], v[136:139], 0
    ds_read_b64_tr_b16 v[104:105], v14 offset:2048
    ds_read_b64_tr_b16 v[106:107], v14 offset:3072
    ds_read_b64_tr_b16 v[108:109], v15 offset:2048
    ds_read_b64_tr_b16 v[110:111], v15 offset:3072
    v_add_u32_e64 v4, s73, v4
    ds_read_b128 v[88:91], v4 offset:0
    v_mul_f32 v72, v2, v72
    v_mul_f32 v64, v72, v64
    v_mul_f32_e64 v65, v72, v65
    v_cvt_pk_bf16_f32 v84, v64, v65
    v_mfma_f32_32x32x16_bf16 v[32:47], v[228:231], v[80:83], v[32:47]
    v_mul_f32 v66, v72, v66
    v_mul_f32 v67, v72, v67
    v_cvt_pk_bf16_f32 v85, v66, v67
    v_mul_f32 v68, v72, v68
    v_mul_f32 v69, v72, v69
    v_mfma_f32_32x32x16_bf16 v[16:31], v[224:227], v[80:83], v[16:31]
    v_cvt_pk_bf16_f32 v86, v68, v69
    v_mul_f32 v70, v72, v70
    v_mul_f32 v71, v72, v71
    v_cvt_pk_bf16_f32 v87, v70, v71
    v_add_f32 v56, s71, v56
    v_rcp_f32_e64 v56, v56
    s_waitcnt vmcnt(4) lgkmcnt(1)
    v_mfma_f32_32x32x16_bf16 v[64:79], v[92:95], v[140:143], 0
    ds_read_b64_tr_b16 v[112:113], v14 offset:8192
    ds_read_b64_tr_b16 v[114:115], v14 offset:9216
    ds_read_b64_tr_b16 v[116:117], v15 offset:8192
    ds_read_b64_tr_b16 v[118:119], v15 offset:9216
    ds_read_b128 v[92:95], v4 offset:544
    v_mul_f32 v56, v2, v56
    v_mul_f32 v48, v56, v48
    v_mul_f32_e64 v49, v56, v49
    v_cvt_pk_bf16_f32 v80, v48, v49
    v_mfma_f32_32x32x16_bf16 v[32:47], v[236:239], v[84:87], v[32:47]
    v_mul_f32 v50, v56, v50
    v_mul_f32 v51, v56, v51
    v_cvt_pk_bf16_f32 v81, v50, v51
    v_mul_f32 v52, v56, v52
    v_mul_f32 v53, v56, v53
    v_mfma_f32_32x32x16_bf16 v[16:31], v[232:235], v[84:87], v[16:31]
    v_cvt_pk_bf16_f32 v82, v52, v53
    v_mul_f32 v54, v56, v54
    v_mul_f32 v55, v56, v55
    v_cvt_pk_bf16_f32 v83, v54, v55
    v_add_f32 v72, s71, v72
    v_rcp_f32_e64 v72, v72
    s_waitcnt vmcnt(3) lgkmcnt(1)
    v_mfma_f32_32x32x16_bf16 v[48:63], v[88:91], v[144:147], 0
    ds_read_b64_tr_b16 v[120:121], v14 offset:10240
    ds_read_b64_tr_b16 v[122:123], v14 offset:11264
    ds_read_b64_tr_b16 v[124:125], v15 offset:10240
    ds_read_b64_tr_b16 v[126:127], v15 offset:11264
    ds_read_b128 v[88:91], v4 offset:2176
    v_mul_f32 v72, v2, v72
    v_mul_f32 v64, v72, v64
    v_mul_f32_e64 v65, v72, v65
    v_cvt_pk_bf16_f32 v84, v64, v65
    v_mfma_f32_32x32x16_bf16 v[32:47], v[244:247], v[80:83], v[32:47]
    v_mul_f32 v66, v72, v66
    v_mul_f32 v67, v72, v67
    v_cvt_pk_bf16_f32 v85, v66, v67
    v_mul_f32 v68, v72, v68
    v_mul_f32 v69, v72, v69
    v_mfma_f32_32x32x16_bf16 v[16:31], v[240:243], v[80:83], v[16:31]
    v_cvt_pk_bf16_f32 v86, v68, v69
    v_mul_f32 v70, v72, v70
    v_mul_f32 v71, v72, v71
    v_cvt_pk_bf16_f32 v87, v70, v71
    v_add_f32 v56, s71, v56
    v_rcp_f32_e64 v56, v56
    s_waitcnt vmcnt(2) lgkmcnt(1)
    v_mfma_f32_32x32x16_bf16 v[64:79], v[92:95], v[148:151], 0
    ds_read_b128 v[92:95], v4 offset:2720
    v_mul_f32 v56, v2, v56
    v_mul_f32 v48, v56, v48
    v_mul_f32_e64 v49, v56, v49
    v_cvt_pk_bf16_f32 v80, v48, v49
    v_mfma_f32_32x32x16_bf16 v[32:47], v[252:255], v[84:87], v[32:47]
    v_mul_f32 v50, v56, v50
    v_mul_f32 v51, v56, v51
    v_cvt_pk_bf16_f32 v81, v50, v51
    v_mul_f32 v52, v56, v52
    v_mul_f32 v53, v56, v53
    v_mfma_f32_32x32x16_bf16 v[16:31], v[248:251], v[84:87], v[16:31]
    v_cvt_pk_bf16_f32 v82, v52, v53
    v_mul_f32 v54, v56, v54
    v_mul_f32 v55, v56, v55
    v_cvt_pk_bf16_f32 v83, v54, v55
    v_add_f32 v72, s71, v72
    v_rcp_f32_e64 v72, v72
    s_waitcnt vmcnt(1) lgkmcnt(1)
    v_mfma_f32_32x32x16_bf16 v[48:63], v[88:91], v[152:155], 0
    v_mul_f32 v72, v2, v72
    v_mul_f32 v64, v72, v64
    v_mul_f32_e64 v65, v72, v65
    v_cvt_pk_bf16_f32 v84, v64, v65
    v_mfma_f32_32x32x16_bf16 v[32:47], v[100:103], v[80:83], v[32:47]
    v_mul_f32 v66, v72, v66
    v_mul_f32 v67, v72, v67
    v_cvt_pk_bf16_f32 v85, v66, v67
    v_mul_f32 v68, v72, v68
    v_mul_f32 v69, v72, v69
    v_mfma_f32_32x32x16_bf16 v[16:31], v[96:99], v[80:83], v[16:31]
    v_cvt_pk_bf16_f32 v86, v68, v69
    v_mul_f32 v70, v72, v70
    v_mul_f32 v71, v72, v71
    v_cvt_pk_bf16_f32 v87, v70, v71
    v_add_f32 v56, s71, v56
    v_rcp_f32_e64 v56, v56
    s_waitcnt vmcnt(0) lgkmcnt(0)
    v_mfma_f32_32x32x16_bf16 v[64:79], v[92:95], v[156:159], 0
    v_mul_f32 v56, v2, v56
    v_mul_f32 v48, v56, v48
    v_mul_f32_e64 v49, v56, v49
    v_cvt_pk_bf16_f32 v80, v48, v49
    v_mfma_f32_32x32x16_bf16 v[32:47], v[108:111], v[84:87], v[32:47]
    v_mul_f32 v50, v56, v50
    v_mul_f32 v51, v56, v51
    v_cvt_pk_bf16_f32 v81, v50, v51
    v_mul_f32 v52, v56, v52
    v_mul_f32 v53, v56, v53
    v_mfma_f32_32x32x16_bf16 v[16:31], v[104:107], v[84:87], v[16:31]
    v_cvt_pk_bf16_f32 v82, v52, v53
    v_mul_f32 v54, v56, v54
    v_mul_f32 v55, v56, v55
    v_cvt_pk_bf16_f32 v83, v54, v55
    v_add_f32 v72, s71, v72
    v_rcp_f32_e64 v72, v72
    s_barrier
    ds_read_b64_tr_b16 v[88:89], v7 offset:0
    ds_read_b64_tr_b16 v[90:91], v7 offset:1024
    ds_read_b64_tr_b16 v[92:93], v7 offset:2048
    ds_read_b64_tr_b16 v[94:95], v7 offset:3072
    v_mul_f32 v72, v2, v72
    v_mul_f32 v64, v72, v64
    v_mul_f32_e64 v65, v72, v65
    v_cvt_pk_bf16_f32 v84, v64, v65
    v_mfma_f32_32x32x16_bf16 v[32:47], v[116:119], v[80:83], v[32:47]
    v_mul_f32 v66, v72, v66
    v_mul_f32 v67, v72, v67
    v_cvt_pk_bf16_f32 v85, v66, v67
    v_mul_f32 v68, v72, v68
    v_mul_f32 v69, v72, v69
    v_mfma_f32_32x32x16_bf16 v[16:31], v[112:115], v[80:83], v[16:31]
    v_cvt_pk_bf16_f32 v86, v68, v69
    v_mul_f32 v70, v72, v70
    v_mul_f32 v71, v72, v71
    v_cvt_pk_bf16_f32 v87, v70, v71
    s_waitcnt lgkmcnt(0)
    s_nop 0
    v_mfma_f32_32x32x16_bf16 v[32:47], v[124:127], v[84:87], v[32:47]
    v_lshlrev_b32_e64 v128, 16, v88
    v_and_b32 v129, 0xffff0000, v88
    v_lshlrev_b32_e64 v130, 16, v89
    v_and_b32 v131, 0xffff0000, v89
    v_lshlrev_b32_e64 v132, 16, v90
    v_mfma_f32_32x32x16_bf16 v[16:31], v[120:123], v[84:87], v[16:31]
    v_and_b32 v133, 0xffff0000, v90
    v_lshlrev_b32_e64 v134, 16, v91
    v_and_b32 v135, 0xffff0000, v91
    v_lshlrev_b32_e64 v136, 16, v92
    v_and_b32 v137, 0xffff0000, v92
    v_lshlrev_b32_e64 v138, 16, v93
    v_and_b32 v139, 0xffff0000, v93
    v_lshlrev_b32_e64 v140, 16, v94
    v_and_b32 v141, 0xffff0000, v94
    v_lshlrev_b32_e64 v142, 16, v95
    v_and_b32 v143, 0xffff0000, v95
    ds_write_b128 v9, v[32:35] offset:0
    ds_write_b128 v9, v[36:39] offset:1024
    ds_write_b128 v9, v[40:43] offset:2048
    ds_write_b128 v9, v[44:47] offset:3072
    v_fma_f32 v16, v12, v128, v16
    v_fma_f32 v17, v12, v129, v17
    v_fma_f32 v18, v12, v130, v18
    v_fma_f32 v19, v12, v131, v19
    v_fma_f32 v20, v12, v132, v20
    v_fma_f32 v21, v12, v133, v21
    v_fma_f32 v22, v12, v134, v22
    v_fma_f32 v23, v12, v135, v23
    v_fma_f32 v24, v12, v136, v24
    v_fma_f32 v25, v12, v137, v25
    v_fma_f32 v26, v12, v138, v26
    v_fma_f32 v27, v12, v139, v27
    v_fma_f32 v28, v12, v140, v28
    v_fma_f32 v29, v12, v141, v29
    v_fma_f32 v30, v12, v142, v30
    v_fma_f32 v31, v12, v143, v31
    s_waitcnt lgkmcnt(0)
    s_barrier
    ds_read_b128 v[32:35], v10 offset:0
    ds_read_b128 v[36:39], v10 offset:1024
    ds_read_b128 v[40:43], v10 offset:2048
    ds_read_b128 v[44:47], v10 offset:3072
    s_waitcnt lgkmcnt(3)
    v_add_f32 v16, v16, v32
    v_add_f32 v17, v17, v33
    v_add_f32 v18, v18, v34
    v_add_f32_e64 v19, v19, v35
    v_cvt_pk_bf16_f32 v48, v16, v17
    v_cvt_pk_bf16_f32 v49, v18, v19
    s_waitcnt lgkmcnt(2)
    v_add_f32 v20, v20, v36
    v_add_f32 v21, v21, v37
    v_add_f32 v22, v22, v38
    v_add_f32_e64 v23, v23, v39
    v_cvt_pk_bf16_f32 v50, v20, v21
    v_cvt_pk_bf16_f32 v51, v22, v23
    s_nop 0
    v_permlane32_swap_b32 v48, v50
    v_permlane32_swap_b32 v49, v51
    buffer_store_dwordx4 v[48:51], v8, s[60:63], s14 offen offset:0
    s_waitcnt lgkmcnt(1)
    v_add_f32 v24, v24, v40
    v_add_f32 v25, v25, v41
    v_add_f32 v26, v26, v42
    v_add_f32 v27, v27, v43
    v_cvt_pk_bf16_f32 v52, v24, v25
    v_cvt_pk_bf16_f32 v53, v26, v27
    s_waitcnt lgkmcnt(0)
    v_add_f32 v28, v28, v44
    v_add_f32 v29, v29, v45
    v_add_f32 v30, v30, v46
    v_add_f32_e64 v31, v31, v47
    v_cvt_pk_bf16_f32 v54, v28, v29
    v_cvt_pk_bf16_f32 v55, v30, v31
    s_nop 0
    v_permlane32_swap_b32 v52, v54
    v_permlane32_swap_b32 v53, v55
    buffer_store_dwordx4 v[52:55], v8, s[60:63], s14 offen offset:32
L_exit:
    s_endpgm
L_end:
.section .rodata,"a"
.p2align 6
.amdhsa_kernel gated_mix__linear_attn_block__ssm_conv_s4__prompt_kernel
  .amdhsa_next_free_vgpr 256
  .amdhsa_next_free_sgpr 102
  .amdhsa_accum_offset 256
  .amdhsa_group_segment_fixed_size 0
  .amdhsa_kernarg_size 128
  .amdhsa_user_sgpr_count 2
  .amdhsa_user_sgpr_kernarg_segment_ptr 1
  .amdhsa_system_sgpr_workgroup_id_x 1
  .amdhsa_float_denorm_mode_32 3
.end_amdhsa_kernel
```
